```python
import torch

def _softmax(x, axis=-1):
    return torch.softmax(x, dim=axis)
def _gelu(x):
    return torch.nn.functional.gelu(x, approximate="tanh")
def _silu(x):
    return torch.nn.functional.silu(x)
def _sigmoid(x):
    return torch.sigmoid(x)
def _layernorm(x, axis=-1, eps=1e-5):
    m = x.mean(dim=axis, keepdim=True)
    v = x.var(dim=axis, keepdim=True, unbiased=False)
    return (x - m) / torch.sqrt(v + eps)
def _scatter_add(tgt, idx, src, axis=0):
    return tgt.clone().index_add_(axis, idx, src)
def _segment_sum(src, seg, n):
    out = torch.zeros((n,) + src.shape[1:], dtype=src.dtype)
    return out.index_add_(0, seg, src)
def _pad(x, pw):
    flat = tuple(v for pair in reversed(pw) for v in pair)
    return torch.nn.functional.pad(x, flat)

kernel_name = 'recurrent_scan__mha_block__glu_gated_reglu__prompt'

def setup_inputs():

    _w = (lambda a: (lambda t: t.to(torch.bfloat16) if t.is_floating_point() else t)(torch.as_tensor(a)))
    def _A_setup():
        B, S, D, H = 1, 2048, 512, 32
        return {
            "x": _w((lambda *s: torch.randn(*s, dtype=torch.bfloat16) * 0.05)(B, S, D)),
            "wqkv": _w((lambda *s: torch.randn(*s, dtype=torch.bfloat16) * 0.2)(D, 3 * D)),
            "wo": _w((lambda *s: torch.randn(*s, dtype=torch.bfloat16) * 0.2)(D, D)),
        }
    _A_in = _A_setup()

    def _B_setup():
        B, S, D, F = 1, 2048, 512, 1792
        return {
            "x": _w((lambda *s: torch.randn(*s, dtype=torch.bfloat16) * 0.05)(B, S, D)),
            "W_gate": _w((lambda *s: torch.randn(*s, dtype=torch.bfloat16) * 0.1)(D, F) * (2.0 / D) ** 0.5),
            "W_up": _w((lambda *s: torch.randn(*s, dtype=torch.bfloat16) * 0.1)(D, F) * (2.0 / D) ** 0.5),
            "W_down": _w((lambda *s: torch.randn(*s, dtype=torch.bfloat16) * 0.1)(F, D) * (1.0 / F) ** 0.5),
        }
    _B_in = _B_setup()

    return {
        "A_x": _A_in["x"],
        "A_wqkv": _A_in["wqkv"],
        "A_wo": _A_in["wo"],
        "B_x": _B_in["x"],
        "B_W_gate": _B_in["W_gate"],
        "B_W_up": _B_in["W_up"],
        "B_W_down": _B_in["W_down"],
    }

def reference(A_x, A_wqkv, A_wo, B_x, B_W_gate, B_W_up, B_W_down):
    def _A_ref(x, wqkv, wo):
        B, S, D = x.shape
        H = 32
        Dh = D // H
        qkv = (lambda x, *d: x.permute(*d))((x @ wqkv).reshape(B, S, 3, H, Dh), 2, 0, 3, 1, 4)
        q, k, v = qkv[0], qkv[1], qkv[2]
        scores = torch.einsum("bhqd,bhkd->bhqk", q, k) * (Dh ** -0.5)
        p = _softmax(scores, axis=-1)
        o = torch.einsum("bhqk,bhkd->bhqd", p, v)
        return (lambda x, *d: x.permute(*d))(o, 0, 2, 1, 3).reshape(B, S, D) @ wo

    def _B_ref(x, W_gate, W_up, W_down):
        gate = torch.einsum("bsd,df->bsf", x, W_gate)
        up = torch.einsum("bsd,df->bsf", x, W_up)
        gate = gate * (lambda x, dt: x.to(dt))(gate > 0, gate.dtype)
        h = gate * up
        return torch.einsum("bsf,fd->bsd", h, W_down)

    x = A_x
    xn = _layernorm(x, axis=-1)
    s = _A_ref(xn, A_wqkv, A_wo)
    g = _silu(_B_ref(xn, B_W_gate, B_W_up, B_W_down))
    return x + s * g
```

```asm
; @launch grid=(256,1,1) block=(512,1,1) lds=163840
.amdgcn_target "amdgcn-amd-amdhsa--gfx950"
.text
.globl recurrent_scan__mha_block__glu_gated_reglu__prompt_kernel
.p2align 8
.type recurrent_scan__mha_block__glu_gated_reglu__prompt_kernel,@function
recurrent_scan__mha_block__glu_gated_reglu__prompt_kernel:
    s_cmp_ge_u32 s2, 256
    s_cbranch_scc1 k_end
    s_load_dwordx4 s[4:7], s[0:1], 0
    s_load_dwordx2 s[14:15], s[0:1], 72
    s_load_dwordx4 s[8:11], s[0:1], 32
    s_load_dwordx4 s[72:75], s[0:1], 48
    s_load_dwordx2 s[12:13], s[0:1], 16
    s_getpc_b64 s[70:71]
    k_pc:
    s_and_b32 s68, s2, 0xf8
    v_add_u32 v26, s68, v0
    v_lshlrev_b32 v26, 7, v26
    v_min_u32 v26, k_last-k_pc, v26
    v_cmp_gt_u32 vcc, 8, v0
    s_and_saveexec_b64 s[68:69], vcc
    s_cbranch_execz k_nopf
    global_load_dword v26, v26, s[70:71]
    k_nopf:
    s_mov_b64 exec, -1
    v_lshrrev_b32 v1, 6, v0
    v_and_b32 v0, 63, v0
    v_readfirstlane_b32 s40, v1
    s_and_b32 s3, s2, 7
    s_lshr_b32 s59, s2, 3
    s_and_b32 s100, s59, 7
    s_and_b32 s98, s3, 3
    s_lshl_b32 s98, s98, 3
    s_add_u32 s98, s98, s100
    s_lshr_b32 s99, s3, 2
    s_lshl_b32 s99, s99, 2
    s_lshr_b32 s68, s59, 3
    s_add_u32 s99, s99, s68
    s_add_u32 s100, s100, s99
    v_lshrrev_b32 v20, 3, v0
    v_and_b32 v21, 7, v0
    v_lshrrev_b32 v1, 5, v0
    s_and_b32 s70, s40, 3
    s_lshl_b32 s101, s70, 10
    v_lshrrev_b32 v22, 4, v0
    v_xor_b32 v22, v22, v21
    v_lshlrev_b32 v22, 4, v22
    v_lshl_add_u32 v196, v20, 10, v22
    s_lshl_b32 s68, s70, 14
    v_add_u32 v196, s68, v196
    v_xor_b32 v197, 64, v196
    v_add_u32 v197, 0x2000, v197
    v_bfe_u32 v31, v0, 4, 1
    v_lshlrev_b32 v31, 2, v31
    v_xor_b32 v31, v31, v21
    v_lshlrev_b32 v31, 4, v31
    s_lshl_b32 s70, s70, 3
    v_add_u32 v29, s70, v20
    v_mul_u32_u24 v30, 3072, v29
    v_add_u32 v30, v30, v31
    s_lshl_b32 s68, s99, 7
    v_add_u32 v30, s68, v30
    s_and_b32 s89, s99, 1
    s_lshl_b32 s89, s89, 2
    s_xor_b32 s89, s89, s40
    v_and_b32 v22, 31, v0
    s_lshl_b32 s68, s89, 13
    v_lshlrev_b32 v11, 4, v21
    v_lshl_add_u32 v11, v20, 10, v11
    v_add_u32 v11, s68, v11
    s_lshl_b32 s57, s98, 16
    s_waitcnt lgkmcnt(0)
    s_mov_b32 s16, s4
    s_and_b32 s17, s5, 0xffff
    s_mov_b32 s18, 0x200000
    s_mov_b32 s19, 0x20000
    s_mov_b32 s20, s6
    s_and_b32 s21, s7, 0xffff
    s_mov_b32 s22, 0x180000
    s_mov_b32 s23, 0x20000
    s_add_u32 s88, s100, 0
    s_and_b32 s88, s88, 7
    s_lshl_b32 s88, s88, 7
    s_add_u32 s88, s88, s57
    buffer_load_dwordx4 v[32:35], v11, s[16:19], s88 offen
    s_add_u32 s88, s100, 1
    s_and_b32 s88, s88, 7
    s_lshl_b32 s88, s88, 7
    s_add_u32 s88, s88, s57
    buffer_load_dwordx4 v[36:39], v11, s[16:19], s88 offen
    s_add_u32 s88, s100, 2
    s_and_b32 s88, s88, 7
    s_lshl_b32 s88, s88, 7
    s_add_u32 s88, s88, s57
    buffer_load_dwordx4 v[40:43], v11, s[16:19], s88 offen
    s_add_u32 s88, s100, 3
    s_and_b32 s88, s88, 7
    s_lshl_b32 s88, s88, 7
    s_add_u32 s88, s88, s57
    buffer_load_dwordx4 v[44:47], v11, s[16:19], s88 offen
    s_add_u32 s88, s100, 4
    s_and_b32 s88, s88, 7
    s_lshl_b32 s88, s88, 7
    s_add_u32 s88, s88, s57
    buffer_load_dwordx4 v[48:51], v11, s[16:19], s88 offen
    s_add_u32 s88, s100, 5
    s_and_b32 s88, s88, 7
    s_lshl_b32 s88, s88, 7
    s_add_u32 s88, s88, s57
    buffer_load_dwordx4 v[52:55], v11, s[16:19], s88 offen
    s_add_u32 s88, s100, 6
    s_and_b32 s88, s88, 7
    s_lshl_b32 s88, s88, 7
    s_add_u32 s88, s88, s57
    buffer_load_dwordx4 v[56:59], v11, s[16:19], s88 offen
    s_add_u32 s88, s100, 7
    s_and_b32 s88, s88, 7
    s_lshl_b32 s88, s88, 7
    s_add_u32 s88, s88, s57
    buffer_load_dwordx4 v[60:63], v11, s[16:19], s88 offen
    s_mov_b32 s32, s14
    s_and_b32 s33, s15, 0xffff
    s_mov_b32 s34, 0x2000000
    s_mov_b32 s35, 0x20000
    s_add_u32 s70, s14, 22118400
    s_addc_u32 s71, s15, 0
    s_load_dword s58, s[70:71], 0
    s_and_b32 s41, s40, 1
    s_bfe_u32 s42, s40, 0x10001
    v_lshrrev_b32 v4, 4, v0
    s_lshl_b32 s68, s41, 2
    v_xor_b32 v4, s68, v4
    v_xor_b32 v4, v4, v21
    v_lshlrev_b32 v4, 4, v4
    v_lshl_add_u32 v4, v20, 7, v4
    s_lshl_b32 s68, s89, 10
    v_add_u32 v4, s68, v4
    v_mov_b32 v12, 0
    v_mov_b32 v13, 0
    v_mov_b32 v14, 0
    v_mov_b32 v15, 0
    v_lshlrev_b32 v2, 4, v0
    v_mov_b32 v19, 0x3f803f80
    s_lshr_b32 s48, s40, 2
    s_lshl_b32 s80, s48, 12
    s_add_u32 s80, s80, s101
    s_mul_i32 s91, s48, 98304
    s_add_u32 m0, s80, 65536
    s_add_u32 s88, s100, 0
    s_and_b32 s88, s88, 7
    s_mul_i32 s59, s88, 196608
    s_add_u32 s59, s59, s91
    buffer_load_dwordx4 v30, s[20:23], s59 offen lds
    s_add_u32 m0, s80, 73728
    s_add_u32 s59, s59, 1024
    buffer_load_dwordx4 v30, s[20:23], s59 offen lds
    s_add_u32 m0, s80, 81920
    s_add_u32 s59, s59, 1024
    buffer_load_dwordx4 v30, s[20:23], s59 offen lds
    v_bfe_u32 v23, v0, 1, 3
    v_xor_b32 v23, v23, v1
    v_lshlrev_b32 v23, 4, v23
    v_lshl_add_u32 v23, v22, 7, v23
    v_bfe_u32 v28, v0, 2, 2
    v_lshlrev_b32 v28, 7, v28
    v_and_b32 v24, 3, v0
    v_lshl_add_u32 v28, v24, 3, v28
    v_bfe_u32 v24, v0, 3, 1
    v_xor_b32 v24, s42, v24
    v_lshl_add_u32 v28, v24, 6, v28
    v_bfe_u32 v27, v0, 4, 1
    v_lshl_add_u32 v28, v27, 5, v28
    s_lshl_b32 s68, s41, 12
    v_add_u32 v5, s68, v23
    v_xor_b32 v6, 32, v5
    v_xor_b32 v7, 64, v5
    v_xor_b32 v8, 96, v5
    v_lshl_add_u32 v9, v1, 10, v28
    v_add_u32 v9, 65536, v9
    v_add_u32 v10, 49152, v9
    s_waitcnt vmcnt(9)
    v_dot2c_f32_bf16 v12, v32, v19
    v_dot2c_f32_bf16 v14, v32, v32
    v_dot2c_f32_bf16 v13, v33, v19
    v_dot2c_f32_bf16 v15, v33, v33
    v_dot2c_f32_bf16 v12, v34, v19
    v_dot2c_f32_bf16 v14, v34, v34
    v_dot2c_f32_bf16 v13, v35, v19
    v_dot2c_f32_bf16 v15, v35, v35
    v_dot2c_f32_bf16 v12, v36, v19
    v_dot2c_f32_bf16 v14, v36, v36
    v_dot2c_f32_bf16 v13, v37, v19
    v_dot2c_f32_bf16 v15, v37, v37
    v_dot2c_f32_bf16 v12, v38, v19
    v_dot2c_f32_bf16 v14, v38, v38
    v_dot2c_f32_bf16 v13, v39, v19
    v_dot2c_f32_bf16 v15, v39, v39
    s_waitcnt vmcnt(7)
    v_dot2c_f32_bf16 v12, v40, v19
    v_dot2c_f32_bf16 v14, v40, v40
    v_dot2c_f32_bf16 v13, v41, v19
    v_dot2c_f32_bf16 v15, v41, v41
    v_dot2c_f32_bf16 v12, v42, v19
    v_dot2c_f32_bf16 v14, v42, v42
    v_dot2c_f32_bf16 v13, v43, v19
    v_dot2c_f32_bf16 v15, v43, v43
    v_dot2c_f32_bf16 v12, v44, v19
    v_dot2c_f32_bf16 v14, v44, v44
    v_dot2c_f32_bf16 v13, v45, v19
    v_dot2c_f32_bf16 v15, v45, v45
    v_dot2c_f32_bf16 v12, v46, v19
    v_dot2c_f32_bf16 v14, v46, v46
    v_dot2c_f32_bf16 v13, v47, v19
    v_dot2c_f32_bf16 v15, v47, v47
    s_waitcnt vmcnt(5)
    v_dot2c_f32_bf16 v12, v48, v19
    v_dot2c_f32_bf16 v14, v48, v48
    v_dot2c_f32_bf16 v13, v49, v19
    v_dot2c_f32_bf16 v15, v49, v49
    v_dot2c_f32_bf16 v12, v50, v19
    v_dot2c_f32_bf16 v14, v50, v50
    v_dot2c_f32_bf16 v13, v51, v19
    v_dot2c_f32_bf16 v15, v51, v51
    v_dot2c_f32_bf16 v12, v52, v19
    v_dot2c_f32_bf16 v14, v52, v52
    v_dot2c_f32_bf16 v13, v53, v19
    v_dot2c_f32_bf16 v15, v53, v53
    v_dot2c_f32_bf16 v12, v54, v19
    v_dot2c_f32_bf16 v14, v54, v54
    v_dot2c_f32_bf16 v13, v55, v19
    v_dot2c_f32_bf16 v15, v55, v55
    s_waitcnt vmcnt(3)
    v_dot2c_f32_bf16 v12, v56, v19
    v_dot2c_f32_bf16 v14, v56, v56
    v_dot2c_f32_bf16 v13, v57, v19
    v_dot2c_f32_bf16 v15, v57, v57
    v_dot2c_f32_bf16 v12, v58, v19
    v_dot2c_f32_bf16 v14, v58, v58
    v_dot2c_f32_bf16 v13, v59, v19
    v_dot2c_f32_bf16 v15, v59, v59
    v_dot2c_f32_bf16 v12, v60, v19
    v_dot2c_f32_bf16 v14, v60, v60
    v_dot2c_f32_bf16 v13, v61, v19
    v_dot2c_f32_bf16 v15, v61, v61
    v_dot2c_f32_bf16 v12, v62, v19
    v_dot2c_f32_bf16 v14, v62, v62
    v_dot2c_f32_bf16 v13, v63, v19
    v_dot2c_f32_bf16 v15, v63, v63
    s_nop 2
    v_add_f32 v12, v12, v13
    v_add_f32 v13, v14, v15
    s_nop 1
    v_add_f32_dpp v12, v12, v12 quad_perm:[1,0,3,2] row_mask:0xf bank_mask:0xf
    v_add_f32_dpp v13, v13, v13 quad_perm:[1,0,3,2] row_mask:0xf bank_mask:0xf
    s_nop 0
    v_add_f32_dpp v12, v12, v12 quad_perm:[2,3,0,1] row_mask:0xf bank_mask:0xf
    v_add_f32_dpp v13, v13, v13 quad_perm:[2,3,0,1] row_mask:0xf bank_mask:0xf
    s_nop 0
    v_add_f32_dpp v12, v12, v12 row_half_mirror row_mask:0xf bank_mask:0xf
    v_add_f32_dpp v13, v13, v13 row_half_mirror row_mask:0xf bank_mask:0xf
    s_nop 0
    v_mul_f32 v12, 0x3b000000, v12
    v_mul_f32 v13, 0x3b000000, v13
    v_fma_f32 v13, -v12, v12, v13
    v_max_f32 v13, 0, v13
    v_cvt_pk_bf16_f32 v13, v13, v13
    v_and_b32 v13, 0xffff0000, v13
    v_add_f32 v13, 0x3727c5ac, v13
    v_cvt_pk_bf16_f32 v13, v13, v13
    v_and_b32 v13, 0xffff0000, v13
    v_sqrt_f32 v13, v13
    v_cvt_pk_bf16_f32 v12, v12, v12
    v_cvt_pk_bf16_f32 v13, v13, v13
    v_and_b32 v13, 0xffff0000, v13
    v_rcp_f32 v14, v13
    v_and_b32 v12, 0xffff0000, v12
    v_mov_b32 v15, v14
    v_mul_f32 v16, -v12, v14
    v_mov_b32 v17, v16
    v_lshlrev_b32 v68, 16, v32
    v_and_b32 v69, 0xffff0000, v32
    v_lshlrev_b32 v70, 16, v33
    v_and_b32 v71, 0xffff0000, v33
    v_pk_fma_f32 v[68:69], v[68:69], v[14:15], v[16:17]
    v_pk_fma_f32 v[70:71], v[70:71], v[14:15], v[16:17]
    v_cvt_pk_bf16_f32 v32, v68, v69
    v_cvt_pk_bf16_f32 v33, v70, v71
    v_lshlrev_b32 v68, 16, v34
    v_and_b32 v69, 0xffff0000, v34
    v_lshlrev_b32 v70, 16, v35
    v_and_b32 v71, 0xffff0000, v35
    v_pk_fma_f32 v[68:69], v[68:69], v[14:15], v[16:17]
    v_pk_fma_f32 v[70:71], v[70:71], v[14:15], v[16:17]
    v_cvt_pk_bf16_f32 v34, v68, v69
    v_cvt_pk_bf16_f32 v35, v70, v71
    ds_write_b128 v4, v[32:35] offset:0
    v_lshlrev_b32 v68, 16, v36
    v_and_b32 v69, 0xffff0000, v36
    v_lshlrev_b32 v70, 16, v37
    v_and_b32 v71, 0xffff0000, v37
    v_pk_fma_f32 v[68:69], v[68:69], v[14:15], v[16:17]
    v_pk_fma_f32 v[70:71], v[70:71], v[14:15], v[16:17]
    v_cvt_pk_bf16_f32 v36, v68, v69
    v_cvt_pk_bf16_f32 v37, v70, v71
    v_lshlrev_b32 v68, 16, v38
    v_and_b32 v69, 0xffff0000, v38
    v_lshlrev_b32 v70, 16, v39
    v_and_b32 v71, 0xffff0000, v39
    v_pk_fma_f32 v[68:69], v[68:69], v[14:15], v[16:17]
    v_pk_fma_f32 v[70:71], v[70:71], v[14:15], v[16:17]
    v_cvt_pk_bf16_f32 v38, v68, v69
    v_cvt_pk_bf16_f32 v39, v70, v71
    ds_write_b128 v4, v[36:39] offset:8192
    v_lshlrev_b32 v68, 16, v40
    v_and_b32 v69, 0xffff0000, v40
    v_lshlrev_b32 v70, 16, v41
    v_and_b32 v71, 0xffff0000, v41
    v_pk_fma_f32 v[68:69], v[68:69], v[14:15], v[16:17]
    v_pk_fma_f32 v[70:71], v[70:71], v[14:15], v[16:17]
    v_cvt_pk_bf16_f32 v40, v68, v69
    v_cvt_pk_bf16_f32 v41, v70, v71
    v_lshlrev_b32 v68, 16, v42
    v_and_b32 v69, 0xffff0000, v42
    v_lshlrev_b32 v70, 16, v43
    v_and_b32 v71, 0xffff0000, v43
    v_pk_fma_f32 v[68:69], v[68:69], v[14:15], v[16:17]
    v_pk_fma_f32 v[70:71], v[70:71], v[14:15], v[16:17]
    v_cvt_pk_bf16_f32 v42, v68, v69
    v_cvt_pk_bf16_f32 v43, v70, v71
    ds_write_b128 v4, v[40:43] offset:16384
    v_lshlrev_b32 v68, 16, v44
    v_and_b32 v69, 0xffff0000, v44
    v_lshlrev_b32 v70, 16, v45
    v_and_b32 v71, 0xffff0000, v45
    v_pk_fma_f32 v[68:69], v[68:69], v[14:15], v[16:17]
    v_pk_fma_f32 v[70:71], v[70:71], v[14:15], v[16:17]
    v_cvt_pk_bf16_f32 v44, v68, v69
    v_cvt_pk_bf16_f32 v45, v70, v71
    v_lshlrev_b32 v68, 16, v46
    v_and_b32 v69, 0xffff0000, v46
    v_lshlrev_b32 v70, 16, v47
    v_and_b32 v71, 0xffff0000, v47
    v_pk_fma_f32 v[68:69], v[68:69], v[14:15], v[16:17]
    v_pk_fma_f32 v[70:71], v[70:71], v[14:15], v[16:17]
    v_cvt_pk_bf16_f32 v46, v68, v69
    v_cvt_pk_bf16_f32 v47, v70, v71
    ds_write_b128 v4, v[44:47] offset:24576
    v_lshlrev_b32 v68, 16, v48
    v_and_b32 v69, 0xffff0000, v48
    v_lshlrev_b32 v70, 16, v49
    v_and_b32 v71, 0xffff0000, v49
    v_pk_fma_f32 v[68:69], v[68:69], v[14:15], v[16:17]
    v_pk_fma_f32 v[70:71], v[70:71], v[14:15], v[16:17]
    v_cvt_pk_bf16_f32 v48, v68, v69
    v_cvt_pk_bf16_f32 v49, v70, v71
    v_lshlrev_b32 v68, 16, v50
    v_and_b32 v69, 0xffff0000, v50
    v_lshlrev_b32 v70, 16, v51
    v_and_b32 v71, 0xffff0000, v51
    v_pk_fma_f32 v[68:69], v[68:69], v[14:15], v[16:17]
    v_pk_fma_f32 v[70:71], v[70:71], v[14:15], v[16:17]
    v_cvt_pk_bf16_f32 v50, v68, v69
    v_cvt_pk_bf16_f32 v51, v70, v71
    ds_write_b128 v4, v[48:51] offset:32768
    v_lshlrev_b32 v68, 16, v52
    v_and_b32 v69, 0xffff0000, v52
    v_lshlrev_b32 v70, 16, v53
    v_and_b32 v71, 0xffff0000, v53
    v_pk_fma_f32 v[68:69], v[68:69], v[14:15], v[16:17]
    v_pk_fma_f32 v[70:71], v[70:71], v[14:15], v[16:17]
    v_cvt_pk_bf16_f32 v52, v68, v69
    v_cvt_pk_bf16_f32 v53, v70, v71
    v_lshlrev_b32 v68, 16, v54
    v_and_b32 v69, 0xffff0000, v54
    v_lshlrev_b32 v70, 16, v55
    v_and_b32 v71, 0xffff0000, v55
    v_pk_fma_f32 v[68:69], v[68:69], v[14:15], v[16:17]
    v_pk_fma_f32 v[70:71], v[70:71], v[14:15], v[16:17]
    v_cvt_pk_bf16_f32 v54, v68, v69
    v_cvt_pk_bf16_f32 v55, v70, v71
    ds_write_b128 v4, v[52:55] offset:40960
    v_lshlrev_b32 v68, 16, v56
    v_and_b32 v69, 0xffff0000, v56
    v_lshlrev_b32 v70, 16, v57
    v_and_b32 v71, 0xffff0000, v57
    v_pk_fma_f32 v[68:69], v[68:69], v[14:15], v[16:17]
    v_pk_fma_f32 v[70:71], v[70:71], v[14:15], v[16:17]
    v_cvt_pk_bf16_f32 v56, v68, v69
    v_cvt_pk_bf16_f32 v57, v70, v71
    v_lshlrev_b32 v68, 16, v58
    v_and_b32 v69, 0xffff0000, v58
    v_lshlrev_b32 v70, 16, v59
    v_and_b32 v71, 0xffff0000, v59
    v_pk_fma_f32 v[68:69], v[68:69], v[14:15], v[16:17]
    v_pk_fma_f32 v[70:71], v[70:71], v[14:15], v[16:17]
    v_cvt_pk_bf16_f32 v58, v68, v69
    v_cvt_pk_bf16_f32 v59, v70, v71
    ds_write_b128 v4, v[56:59] offset:49152
    v_lshlrev_b32 v68, 16, v60
    v_and_b32 v69, 0xffff0000, v60
    v_lshlrev_b32 v70, 16, v61
    v_and_b32 v71, 0xffff0000, v61
    v_pk_fma_f32 v[68:69], v[68:69], v[14:15], v[16:17]
    v_pk_fma_f32 v[70:71], v[70:71], v[14:15], v[16:17]
    v_cvt_pk_bf16_f32 v60, v68, v69
    v_cvt_pk_bf16_f32 v61, v70, v71
    v_lshlrev_b32 v68, 16, v62
    v_and_b32 v69, 0xffff0000, v62
    v_lshlrev_b32 v70, 16, v63
    v_and_b32 v71, 0xffff0000, v63
    v_pk_fma_f32 v[68:69], v[68:69], v[14:15], v[16:17]
    v_pk_fma_f32 v[70:71], v[70:71], v[14:15], v[16:17]
    v_cvt_pk_bf16_f32 v62, v68, v69
    v_cvt_pk_bf16_f32 v63, v70, v71
    ds_write_b128 v4, v[60:63] offset:57344
    s_waitcnt vmcnt(0)
    s_cmp_ge_u32 s40, 4
    s_cbranch_scc1 p1_nop
    s_add_u32 m0, s101, 90112
    s_add_u32 s88, s100, 1
    s_and_b32 s88, s88, 7
    s_mul_i32 s59, s88, 196608
    buffer_load_dwordx4 v30, s[20:23], s59 offen lds
    s_add_u32 m0, s101, 98304
    s_add_u32 s59, s59, 1024
    buffer_load_dwordx4 v30, s[20:23], s59 offen lds
    s_add_u32 m0, s101, 106496
    s_add_u32 s59, s59, 1024
    buffer_load_dwordx4 v30, s[20:23], s59 offen lds
    s_add_u32 m0, s101, 94208
    s_add_u32 s88, s100, 1
    s_and_b32 s88, s88, 7
    s_mul_i32 s59, s88, 196608
    s_add_u32 s59, s59, 98304
    buffer_load_dwordx4 v30, s[20:23], s59 offen lds
    s_add_u32 m0, s101, 102400
    s_add_u32 s59, s59, 1024
    buffer_load_dwordx4 v30, s[20:23], s59 offen lds
    s_add_u32 m0, s101, 110592
    s_add_u32 s59, s59, 1024
    buffer_load_dwordx4 v30, s[20:23], s59 offen lds
    v_mov_b32 v64, -1
    v_mov_b32 v65, -1
    v_mov_b32 v66, -1
    v_mov_b32 v67, -1
    s_lshl_b32 s68, s98, 1
    s_add_u32 s68, s68, s41
    s_lshl_b32 s59, s99, 1
    s_add_u32 s59, s59, s42
    s_lshl_b32 s69, s68, 4
    s_add_u32 s69, s69, s59
    s_lshl_b32 s69, s69, 11
    s_add_u32 s69, s69, 13631488
    buffer_store_dwordx4 v[64:67], v2, s[32:35], s69 offen sc1
    buffer_store_dwordx4 v[64:67], v2, s[32:35], s69 offen offset:1024 sc1
p1_nop:
    s_waitcnt lgkmcnt(0)
    s_barrier
    s_add_u32 s58, s58, 1
    s_cmp_ge_u32 s40, 4
    s_cbranch_scc1 p1_help
    s_setprio 1
    s_lshl_b32 s68, s101, 1
    v_add_u32 v18, s68, v2
    ds_read_b128 v[48:51], v18
    ds_read_b128 v[52:55], v18 offset:1024
    ds_read_b128 v[64:67], v5 offset:0
    ds_read_b64_tr_b16 v[68:69], v9 offset:0
    ds_read_b64_tr_b16 v[70:71], v9 offset:512
    ds_read_b64_tr_b16 v[72:73], v9 offset:8192
    ds_read_b64_tr_b16 v[74:75], v9 offset:8704
    ds_read_b64_tr_b16 v[76:77], v9 offset:16384
    ds_read_b64_tr_b16 v[78:79], v9 offset:16896
    ds_read_b128 v[80:83], v6 offset:0
    ds_read_b64_tr_b16 v[84:85], v9 offset:2048
    ds_read_b64_tr_b16 v[86:87], v9 offset:2560
    ds_read_b64_tr_b16 v[88:89], v9 offset:10240
    ds_read_b64_tr_b16 v[90:91], v9 offset:10752
    ds_read_b64_tr_b16 v[92:93], v9 offset:18432
    ds_read_b64_tr_b16 v[94:95], v9 offset:18944
    s_and_b32 s59, s100, 7
    s_lshl_b32 s59, s59, 7
    s_add_u32 s59, s59, s57
    s_add_u32 s59, s59, 23068672
    s_waitcnt lgkmcnt(7)
    v_mfma_f32_32x32x16_bf16 v[128:143], v[76:79], v[64:67], 0
    ds_read_b128 v[32:35], v7 offset:0
    ds_read_b64_tr_b16 v[36:37], v9 offset:4096
    v_mfma_f32_32x32x16_bf16 v[112:127], v[72:75], v[64:67], 0
    ds_read_b64_tr_b16 v[38:39], v9 offset:4608
    ds_read_b64_tr_b16 v[40:41], v9 offset:12288
    ds_read_b64_tr_b16 v[42:43], v9 offset:12800
    v_mfma_f32_32x32x16_bf16 v[96:111], v[68:71], v[64:67], 0
    ds_read_b64_tr_b16 v[44:45], v9 offset:20480
    ds_read_b64_tr_b16 v[46:47], v9 offset:20992
    buffer_store_dwordx4 v[48:51], v196, s[32:35], s59 offen sc1
    s_waitcnt lgkmcnt(7)
    v_mfma_f32_32x32x16_bf16 v[128:143], v[92:95], v[80:83], v[128:143]
    ds_read_b128 v[64:67], v8 offset:0
    ds_read_b64_tr_b16 v[68:69], v9 offset:6144
    v_mfma_f32_32x32x16_bf16 v[112:127], v[88:91], v[80:83], v[112:127]
    ds_read_b64_tr_b16 v[70:71], v9 offset:6656
    ds_read_b64_tr_b16 v[72:73], v9 offset:14336
    ds_read_b64_tr_b16 v[74:75], v9 offset:14848
    v_mfma_f32_32x32x16_bf16 v[96:111], v[84:87], v[80:83], v[96:111]
    ds_read_b64_tr_b16 v[76:77], v9 offset:22528
    ds_read_b64_tr_b16 v[78:79], v9 offset:23040
    buffer_store_dwordx4 v[52:55], v197, s[32:35], s59 offen sc1
    s_waitcnt vmcnt(4) lgkmcnt(7)
    s_barrier
    v_mfma_f32_32x32x16_bf16 v[128:143], v[44:47], v[32:35], v[128:143]
    ds_read_b128 v[80:83], v5 offset:8192
    ds_read_b64_tr_b16 v[84:85], v9 offset:24576
    v_mfma_f32_32x32x16_bf16 v[112:127], v[40:43], v[32:35], v[112:127]
    ds_read_b64_tr_b16 v[86:87], v9 offset:25088
    ds_read_b64_tr_b16 v[88:89], v9 offset:32768
    ds_read_b64_tr_b16 v[90:91], v9 offset:33280
    v_mfma_f32_32x32x16_bf16 v[96:111], v[36:39], v[32:35], v[96:111]
    ds_read_b64_tr_b16 v[92:93], v9 offset:40960
    ds_read_b64_tr_b16 v[94:95], v9 offset:41472
    s_mov_b32 s24, s8
    s_and_b32 s25, s9, 0xffff
    s_mov_b32 s26, 0x1c0000
    s_mov_b32 s27, 0x20000
    s_mov_b32 s28, s10
    s_waitcnt lgkmcnt(7)
    v_mfma_f32_32x32x16_bf16 v[128:143], v[76:79], v[64:67], v[128:143]
    ds_read_b128 v[32:35], v6 offset:8192
    ds_read_b64_tr_b16 v[36:37], v9 offset:26624
    v_mfma_f32_32x32x16_bf16 v[112:127], v[72:75], v[64:67], v[112:127]
    ds_read_b64_tr_b16 v[38:39], v9 offset:27136
    ds_read_b64_tr_b16 v[40:41], v9 offset:34816
    ds_read_b64_tr_b16 v[42:43], v9 offset:35328
    v_mfma_f32_32x32x16_bf16 v[96:111], v[68:71], v[64:67], v[96:111]
    ds_read_b64_tr_b16 v[44:45], v9 offset:43008
    ds_read_b64_tr_b16 v[46:47], v9 offset:43520
    s_and_b32 s29, s11, 0xffff
    s_mov_b32 s30, 0x1c0000
    s_mov_b32 s31, 0x20000
    s_mov_b32 s36, s14
    s_and_b32 s37, s15, 0xffff
    s_waitcnt lgkmcnt(7)
    v_mfma_f32_32x32x16_bf16 v[128:143], v[92:95], v[80:83], v[128:143]
    ds_read_b128 v[64:67], v7 offset:8192
    ds_read_b64_tr_b16 v[68:69], v9 offset:28672
    v_mfma_f32_32x32x16_bf16 v[112:127], v[88:91], v[80:83], v[112:127]
    ds_read_b64_tr_b16 v[70:71], v9 offset:29184
    ds_read_b64_tr_b16 v[72:73], v9 offset:36864
    ds_read_b64_tr_b16 v[74:75], v9 offset:37376
    v_mfma_f32_32x32x16_bf16 v[96:111], v[84:87], v[80:83], v[96:111]
    ds_read_b64_tr_b16 v[76:77], v9 offset:45056
    ds_read_b64_tr_b16 v[78:79], v9 offset:45568
    s_mov_b32 s38, 0x2000000
    s_mov_b32 s39, 0x20000
    s_mov_b32 s76, s72
    s_and_b32 s77, s73, 0xffff
    s_mov_b32 s78, 0x1c0000
    s_waitcnt lgkmcnt(7)
    v_mfma_f32_32x32x16_bf16 v[128:143], v[44:47], v[32:35], v[128:143]
    ds_read_b128 v[80:83], v8 offset:8192
    ds_read_b64_tr_b16 v[84:85], v9 offset:30720
    v_mfma_f32_32x32x16_bf16 v[112:127], v[40:43], v[32:35], v[112:127]
    ds_read_b64_tr_b16 v[86:87], v9 offset:31232
    ds_read_b64_tr_b16 v[88:89], v9 offset:38912
    ds_read_b64_tr_b16 v[90:91], v9 offset:39424
    v_mfma_f32_32x32x16_bf16 v[96:111], v[36:39], v[32:35], v[96:111]
    ds_read_b64_tr_b16 v[92:93], v9 offset:47104
    ds_read_b64_tr_b16 v[94:95], v9 offset:47616
    s_mov_b32 s79, 0x20000
    s_mov_b32 s60, s12
    s_and_b32 s61, s13, 0xffff
    s_mov_b32 s62, 0x80000
    s_mov_b32 s63, 0x20000
    s_waitcnt lgkmcnt(7)
    s_barrier
    v_mfma_f32_32x32x16_bf16 v[128:143], v[76:79], v[64:67], v[128:143]
    ds_read_b128 v[32:35], v5 offset:16384
    ds_read_b64_tr_b16 v[36:37], v10 offset:0
    v_mfma_f32_32x32x16_bf16 v[112:127], v[72:75], v[64:67], v[112:127]
    ds_read_b64_tr_b16 v[38:39], v10 offset:512
    ds_read_b64_tr_b16 v[40:41], v10 offset:8192
    ds_read_b64_tr_b16 v[42:43], v10 offset:8704
    v_mfma_f32_32x32x16_bf16 v[96:111], v[68:71], v[64:67], v[96:111]
    ds_read_b64_tr_b16 v[44:45], v10 offset:16384
    ds_read_b64_tr_b16 v[46:47], v10 offset:16896
    s_mov_b32 s64, s74
    s_and_b32 s65, s75, 0xffff
    s_mov_b32 s66, 0x200000
    s_mov_b32 s67, 0x20000
    s_bfe_u32 s75, s2, 0x20003
    s_waitcnt lgkmcnt(7)
    v_mfma_f32_32x32x16_bf16 v[128:143], v[92:95], v[80:83], v[128:143]
    ds_read_b128 v[64:67], v6 offset:16384
    ds_read_b64_tr_b16 v[68:69], v10 offset:2048
    v_mfma_f32_32x32x16_bf16 v[112:127], v[88:91], v[80:83], v[112:127]
    ds_read_b64_tr_b16 v[70:71], v10 offset:2560
    ds_read_b64_tr_b16 v[72:73], v10 offset:10240
    ds_read_b64_tr_b16 v[74:75], v10 offset:10752
    v_mfma_f32_32x32x16_bf16 v[96:111], v[84:87], v[80:83], v[96:111]
    ds_read_b64_tr_b16 v[76:77], v10 offset:18432
    ds_read_b64_tr_b16 v[78:79], v10 offset:18944
    s_lshl_b32 s43, s3, 2
    s_add_u32 s43, s43, s75
    s_lshr_b32 s44, s2, 5
    s_lshl_b32 s45, s44, 3
    s_add_u32 s45, s45, s40
    s_waitcnt lgkmcnt(7)
    v_mfma_f32_32x32x16_bf16 v[128:143], v[44:47], v[32:35], v[128:143]
    ds_read_b128 v[80:83], v7 offset:16384
    ds_read_b64_tr_b16 v[84:85], v10 offset:4096
    v_mfma_f32_32x32x16_bf16 v[112:127], v[40:43], v[32:35], v[112:127]
    ds_read_b64_tr_b16 v[86:87], v10 offset:4608
    ds_read_b64_tr_b16 v[88:89], v10 offset:12288
    ds_read_b64_tr_b16 v[90:91], v10 offset:12800
    v_mfma_f32_32x32x16_bf16 v[96:111], v[36:39], v[32:35], v[96:111]
    ds_read_b64_tr_b16 v[92:93], v10 offset:20480
    ds_read_b64_tr_b16 v[94:95], v10 offset:20992
    s_lshr_b32 s46, s3, 1
    s_lshl_b32 s46, s46, 2
    s_add_u32 s46, s46, s75
    s_and_b32 s47, s3, 1
    s_mul_i32 s47, s47, 7
    s_waitcnt lgkmcnt(7)
    v_mfma_f32_32x32x16_bf16 v[128:143], v[76:79], v[64:67], v[128:143]
    ds_read_b128 v[32:35], v8 offset:16384
    ds_read_b64_tr_b16 v[36:37], v10 offset:6144
    v_mfma_f32_32x32x16_bf16 v[112:127], v[72:75], v[64:67], v[112:127]
    ds_read_b64_tr_b16 v[38:39], v10 offset:6656
    ds_read_b64_tr_b16 v[40:41], v10 offset:14336
    ds_read_b64_tr_b16 v[42:43], v10 offset:14848
    v_mfma_f32_32x32x16_bf16 v[96:111], v[68:71], v[64:67], v[96:111]
    ds_read_b64_tr_b16 v[44:45], v10 offset:22528
    ds_read_b64_tr_b16 v[46:47], v10 offset:23040
    s_add_u32 s47, s47, s44
    s_lshl_b32 s49, s43, 17
    s_add_u32 s49, s49, s101
    s_add_u32 s49, s49, 2097152
    s_lshl_b32 s50, s46, 17
    s_waitcnt vmcnt(0) lgkmcnt(7)
    s_barrier
    v_mfma_f32_32x32x16_bf16 v[128:143], v[92:95], v[80:83], v[128:143]
    ds_read_b128 v[64:67], v5 offset:24576
    ds_read_b64_tr_b16 v[68:69], v10 offset:24576
    v_mfma_f32_32x32x16_bf16 v[112:127], v[88:91], v[80:83], v[112:127]
    ds_read_b64_tr_b16 v[70:71], v10 offset:25088
    ds_read_b64_tr_b16 v[72:73], v10 offset:32768
    ds_read_b64_tr_b16 v[74:75], v10 offset:33280
    v_mfma_f32_32x32x16_bf16 v[96:111], v[84:87], v[80:83], v[96:111]
    ds_read_b64_tr_b16 v[76:77], v10 offset:40960
    ds_read_b64_tr_b16 v[78:79], v10 offset:41472
    s_add_u32 s50, s50, 23068672
    v_mul_u32_u24 v192, 3584, v29
    v_add_u32 v192, v192, v31
    s_lshl_b32 s74, s47, 8
    v_add_u32 v192, s74, v192
    s_lshl_b32 s59, s98, 10
    s_lshl_b32 s88, s99, 7
    s_add_u32 s59, s59, s88
    s_add_u32 s59, s59, 22020096
    s_cmp_eq_u32 s40, 0
    s_cselect_b32 s59, s59, 0x7ffffff0
    v_mov_b32 v60, s58
    v_mov_b32 v61, 0
    s_mov_b64 exec, 1
    buffer_store_dword v60, v61, s[32:35], s59 offen sc1
    s_mov_b64 exec, -1
    s_waitcnt lgkmcnt(7)
    v_mfma_f32_32x32x16_bf16 v[128:143], v[44:47], v[32:35], v[128:143]
    ds_read_b128 v[80:83], v6 offset:24576
    ds_read_b64_tr_b16 v[84:85], v10 offset:26624
    v_mfma_f32_32x32x16_bf16 v[112:127], v[40:43], v[32:35], v[112:127]
    ds_read_b64_tr_b16 v[86:87], v10 offset:27136
    ds_read_b64_tr_b16 v[88:89], v10 offset:34816
    ds_read_b64_tr_b16 v[90:91], v10 offset:35328
    v_mfma_f32_32x32x16_bf16 v[96:111], v[36:39], v[32:35], v[96:111]
    ds_read_b64_tr_b16 v[92:93], v10 offset:43008
    ds_read_b64_tr_b16 v[94:95], v10 offset:43520
    v_xor_b32 v193, 32, v192
    s_lshr_b32 s74, s101, 5
    v_add_u32 v29, s74, v20
    v_lshl_add_u32 v194, v29, 10, v31
    s_lshl_b32 s74, s44, 7
    s_waitcnt lgkmcnt(7)
    v_mfma_f32_32x32x16_bf16 v[128:143], v[76:79], v[64:67], v[128:143]
    ds_read_b128 v[32:35], v7 offset:24576
    ds_read_b64_tr_b16 v[36:37], v10 offset:28672
    v_mfma_f32_32x32x16_bf16 v[112:127], v[72:75], v[64:67], v[112:127]
    ds_read_b64_tr_b16 v[38:39], v10 offset:29184
    ds_read_b64_tr_b16 v[40:41], v10 offset:36864
    ds_read_b64_tr_b16 v[42:43], v10 offset:37376
    v_mfma_f32_32x32x16_bf16 v[96:111], v[68:71], v[64:67], v[96:111]
    ds_read_b64_tr_b16 v[44:45], v10 offset:45056
    ds_read_b64_tr_b16 v[46:47], v10 offset:45568
    v_add_u32 v194, s74, v194
    s_mul_i32 s51, s43, 229376
    s_lshl_b32 s74, s101, 2
    s_add_u32 s51, s51, s74
    s_add_u32 s51, s51, 6291456
    s_waitcnt lgkmcnt(7)
    v_mfma_f32_32x32x16_bf16 v[128:143], v[92:95], v[80:83], v[128:143]
    ds_read_b128 v[64:67], v8 offset:24576
    ds_read_b64_tr_b16 v[68:69], v10 offset:30720
    v_mfma_f32_32x32x16_bf16 v[112:127], v[88:91], v[80:83], v[112:127]
    ds_read_b64_tr_b16 v[70:71], v10 offset:31232
    ds_read_b64_tr_b16 v[72:73], v10 offset:38912
    ds_read_b64_tr_b16 v[74:75], v10 offset:39424
    v_mfma_f32_32x32x16_bf16 v[96:111], v[84:87], v[80:83], v[96:111]
    ds_read_b64_tr_b16 v[76:77], v10 offset:47104
    ds_read_b64_tr_b16 v[78:79], v10 offset:47616
    v_and_b32 v3, 15, v0
    v_lshlrev_b32 v3, 4, v3
    v_lshl_add_u32 v3, v1, 8, v3
    v_add_u32 v3, 132096, v3
    v_add_u32 v206, 131072, v2
    s_waitcnt lgkmcnt(7)
    s_barrier
    v_mfma_f32_32x32x16_bf16 v[128:143], v[44:47], v[32:35], v[128:143]
    ds_read_b128 v[80:83], v5 offset:32768
    ds_read_b64_tr_b16 v[84:85], v9 offset:0
    v_mfma_f32_32x32x16_bf16 v[112:127], v[40:43], v[32:35], v[112:127]
    ds_read_b64_tr_b16 v[86:87], v9 offset:512
    ds_read_b64_tr_b16 v[88:89], v9 offset:8192
    ds_read_b64_tr_b16 v[90:91], v9 offset:8704
    v_mfma_f32_32x32x16_bf16 v[96:111], v[36:39], v[32:35], v[96:111]
    ds_read_b64_tr_b16 v[92:93], v9 offset:16384
    ds_read_b64_tr_b16 v[94:95], v9 offset:16896
    v_mov_b32 v207, 0xdddd
    s_mov_b32 s52, 0xffff
    s_mov_b32 s53, 0xffff
    s_lshl_b32 s74, s41, 13
    v_add_u32 v236, s74, v23
    s_waitcnt lgkmcnt(7)
    v_mfma_f32_32x32x16_bf16 v[128:143], v[76:79], v[64:67], v[128:143]
    ds_read_b128 v[32:35], v6 offset:32768
    ds_read_b64_tr_b16 v[36:37], v9 offset:2048
    v_mfma_f32_32x32x16_bf16 v[112:127], v[72:75], v[64:67], v[112:127]
    ds_read_b64_tr_b16 v[38:39], v9 offset:2560
    ds_read_b64_tr_b16 v[40:41], v9 offset:10240
    ds_read_b64_tr_b16 v[42:43], v9 offset:10752
    v_mfma_f32_32x32x16_bf16 v[96:111], v[68:71], v[64:67], v[96:111]
    ds_read_b64_tr_b16 v[44:45], v9 offset:18432
    ds_read_b64_tr_b16 v[46:47], v9 offset:18944
    v_xor_b32 v237, 32, v236
    v_xor_b32 v238, 64, v236
    v_xor_b32 v239, 96, v236
    v_add_u32 v232, 0x10000, v236
    v_add_u32 v233, 0x10000, v237
    s_waitcnt lgkmcnt(7)
    v_mfma_f32_32x32x16_bf16 v[128:143], v[92:95], v[80:83], v[128:143]
    ds_read_b128 v[64:67], v7 offset:32768
    ds_read_b64_tr_b16 v[68:69], v9 offset:4096
    v_mfma_f32_32x32x16_bf16 v[112:127], v[88:91], v[80:83], v[112:127]
    ds_read_b64_tr_b16 v[70:71], v9 offset:4608
    ds_read_b64_tr_b16 v[72:73], v9 offset:12288
    ds_read_b64_tr_b16 v[74:75], v9 offset:12800
    v_mfma_f32_32x32x16_bf16 v[96:111], v[84:87], v[80:83], v[96:111]
    ds_read_b64_tr_b16 v[76:77], v9 offset:20480
    ds_read_b64_tr_b16 v[78:79], v9 offset:20992
    v_add_u32 v234, 0x10000, v238
    v_add_u32 v235, 0x10000, v239
    v_lshl_add_u32 v200, v27, 13, v28
    v_lshl_add_u32 v200, v1, 10, v200
    s_lshl_b32 s74, s48, 14
    s_waitcnt lgkmcnt(7)
    v_mfma_f32_32x32x16_bf16 v[128:143], v[44:47], v[32:35], v[128:143]
    ds_read_b128 v[80:83], v8 offset:32768
    ds_read_b64_tr_b16 v[84:85], v9 offset:6144
    v_mfma_f32_32x32x16_bf16 v[112:127], v[40:43], v[32:35], v[112:127]
    ds_read_b64_tr_b16 v[86:87], v9 offset:6656
    ds_read_b64_tr_b16 v[88:89], v9 offset:14336
    ds_read_b64_tr_b16 v[90:91], v9 offset:14848
    v_mfma_f32_32x32x16_bf16 v[96:111], v[36:39], v[32:35], v[96:111]
    ds_read_b64_tr_b16 v[92:93], v9 offset:22528
    ds_read_b64_tr_b16 v[94:95], v9 offset:23040
    s_add_u32 s74, s74, 16384
    v_add_u32 v200, s74, v200
    v_xor_b32 v201, 32, v200
    v_add_u32 v198, 0x10000, v200
    v_add_u32 v199, 0x10000, v201
    s_waitcnt lgkmcnt(7)
    s_barrier
    v_mfma_f32_32x32x16_bf16 v[128:143], v[76:79], v[64:67], v[128:143]
    ds_read_b128 v[32:35], v5 offset:40960
    ds_read_b64_tr_b16 v[36:37], v9 offset:24576
    v_mfma_f32_32x32x16_bf16 v[112:127], v[72:75], v[64:67], v[112:127]
    ds_read_b64_tr_b16 v[38:39], v9 offset:25088
    ds_read_b64_tr_b16 v[40:41], v9 offset:32768
    ds_read_b64_tr_b16 v[42:43], v9 offset:33280
    v_mfma_f32_32x32x16_bf16 v[96:111], v[68:71], v[64:67], v[96:111]
    ds_read_b64_tr_b16 v[44:45], v9 offset:40960
    ds_read_b64_tr_b16 v[46:47], v9 offset:41472
    v_lshl_add_u32 v204, v1, 9, v28
    s_lshl_b32 s74, s42, 6
    v_xor_b32 v204, s74, v204
    s_lshl_b32 s74, s101, 3
    v_add_u32 v204, s74, v204
    s_waitcnt lgkmcnt(7)
    v_mfma_f32_32x32x16_bf16 v[128:143], v[92:95], v[80:83], v[128:143]
    ds_read_b128 v[64:67], v6 offset:40960
    ds_read_b64_tr_b16 v[68:69], v9 offset:26624
    v_mfma_f32_32x32x16_bf16 v[112:127], v[88:91], v[80:83], v[112:127]
    ds_read_b64_tr_b16 v[70:71], v9 offset:27136
    ds_read_b64_tr_b16 v[72:73], v9 offset:34816
    ds_read_b64_tr_b16 v[74:75], v9 offset:35328
    v_mfma_f32_32x32x16_bf16 v[96:111], v[84:87], v[80:83], v[96:111]
    ds_read_b64_tr_b16 v[76:77], v9 offset:43008
    ds_read_b64_tr_b16 v[78:79], v9 offset:43520
    v_xor_b32 v205, 64, v204
    v_add_u32 v202, 0x10000, v204
    v_add_u32 v203, 0x10000, v205
    s_lshl_b32 s54, s46, 2
    s_lshl_b32 s74, s41, 1
    s_waitcnt lgkmcnt(7)
    v_mfma_f32_32x32x16_bf16 v[128:143], v[44:47], v[32:35], v[128:143]
    ds_read_b128 v[80:83], v7 offset:40960
    ds_read_b64_tr_b16 v[84:85], v9 offset:28672
    v_mfma_f32_32x32x16_bf16 v[112:127], v[40:43], v[32:35], v[112:127]
    ds_read_b64_tr_b16 v[86:87], v9 offset:29184
    ds_read_b64_tr_b16 v[88:89], v9 offset:36864
    ds_read_b64_tr_b16 v[90:91], v9 offset:37376
    v_mfma_f32_32x32x16_bf16 v[96:111], v[36:39], v[32:35], v[96:111]
    ds_read_b64_tr_b16 v[92:93], v9 offset:45056
    ds_read_b64_tr_b16 v[94:95], v9 offset:45568
    s_add_u32 s54, s54, s74
    s_mul_i32 s54, s54, 112
    s_lshl_b32 s74, s47, 3
    s_add_u32 s54, s54, s74
    s_and_b32 s74, s40, 6
    s_waitcnt lgkmcnt(7)
    v_mfma_f32_32x32x16_bf16 v[128:143], v[76:79], v[64:67], v[128:143]
    ds_read_b128 v[32:35], v8 offset:40960
    ds_read_b64_tr_b16 v[36:37], v9 offset:30720
    v_mfma_f32_32x32x16_bf16 v[112:127], v[72:75], v[64:67], v[112:127]
    ds_read_b64_tr_b16 v[38:39], v9 offset:31232
    ds_read_b64_tr_b16 v[40:41], v9 offset:38912
    ds_read_b64_tr_b16 v[42:43], v9 offset:39424
    v_mfma_f32_32x32x16_bf16 v[96:111], v[68:71], v[64:67], v[96:111]
    ds_read_b64_tr_b16 v[44:45], v9 offset:47104
    ds_read_b64_tr_b16 v[46:47], v9 offset:47616
    s_add_u32 s54, s54, s74
    s_lshl_b32 s54, s54, 10
    s_add_u32 s54, s54, 6291456
    s_add_u32 s55, s54, 114688
    s_lshl_b32 s81, s48, 12
    s_waitcnt lgkmcnt(0)
    s_barrier
    v_mfma_f32_32x32x16_bf16 v[128:143], v[92:95], v[80:83], v[128:143]
    ds_read_b128 v[64:67], v5 offset:49152
    ds_read_b64_tr_b16 v[68:69], v10 offset:0
    v_mfma_f32_32x32x16_bf16 v[112:127], v[88:91], v[80:83], v[112:127]
    ds_read_b64_tr_b16 v[70:71], v10 offset:512
    ds_read_b64_tr_b16 v[72:73], v10 offset:8192
    ds_read_b64_tr_b16 v[74:75], v10 offset:8704
    v_mfma_f32_32x32x16_bf16 v[96:111], v[84:87], v[80:83], v[96:111]
    ds_read_b64_tr_b16 v[76:77], v10 offset:16384
    ds_read_b64_tr_b16 v[78:79], v10 offset:16896
    s_add_u32 s81, s81, s49
    s_lshl_b32 s82, s48, 16
    s_add_u32 s82, s82, s50
    s_mul_i32 s83, s48, 114688
    s_lshl_b32 s84, s48, 17
    s_waitcnt lgkmcnt(7)
    v_mfma_f32_32x32x16_bf16 v[128:143], v[44:47], v[32:35], v[128:143]
    ds_read_b128 v[80:83], v6 offset:49152
    ds_read_b64_tr_b16 v[84:85], v10 offset:2048
    v_mfma_f32_32x32x16_bf16 v[112:127], v[40:43], v[32:35], v[112:127]
    ds_read_b64_tr_b16 v[86:87], v10 offset:2560
    ds_read_b64_tr_b16 v[88:89], v10 offset:10240
    ds_read_b64_tr_b16 v[90:91], v10 offset:10752
    v_mfma_f32_32x32x16_bf16 v[96:111], v[36:39], v[32:35], v[96:111]
    ds_read_b64_tr_b16 v[92:93], v10 offset:18432
    ds_read_b64_tr_b16 v[94:95], v10 offset:18944
    s_mul_i32 s85, s48, 114688
    s_add_u32 s85, s85, s51
    s_lshr_b32 s86, s46, 1
    s_mul_i32 s74, s43, 37
    s_lshr_b32 s74, s74, 8
    s_waitcnt lgkmcnt(7)
    v_mfma_f32_32x32x16_bf16 v[128:143], v[76:79], v[64:67], v[128:143]
    ds_read_b128 v[32:35], v7 offset:49152
    ds_read_b64_tr_b16 v[36:37], v10 offset:4096
    v_mfma_f32_32x32x16_bf16 v[112:127], v[72:75], v[64:67], v[112:127]
    ds_read_b64_tr_b16 v[38:39], v10 offset:4608
    ds_read_b64_tr_b16 v[40:41], v10 offset:12288
    ds_read_b64_tr_b16 v[42:43], v10 offset:12800
    v_mfma_f32_32x32x16_bf16 v[96:111], v[68:71], v[64:67], v[96:111]
    ds_read_b64_tr_b16 v[44:45], v10 offset:20480
    ds_read_b64_tr_b16 v[46:47], v10 offset:20992
    s_mul_i32 s74, s74, 7
    s_sub_u32 s87, s43, s74
    s_waitcnt lgkmcnt(7)
    v_mfma_f32_32x32x16_bf16 v[128:143], v[92:95], v[80:83], v[128:143]
    ds_read_b128 v[64:67], v8 offset:49152
    ds_read_b64_tr_b16 v[68:69], v10 offset:6144
    v_mfma_f32_32x32x16_bf16 v[112:127], v[88:91], v[80:83], v[112:127]
    ds_read_b64_tr_b16 v[70:71], v10 offset:6656
    ds_read_b64_tr_b16 v[72:73], v10 offset:14336
    ds_read_b64_tr_b16 v[74:75], v10 offset:14848
    v_mfma_f32_32x32x16_bf16 v[96:111], v[84:87], v[80:83], v[96:111]
    ds_read_b64_tr_b16 v[76:77], v10 offset:22528
    ds_read_b64_tr_b16 v[78:79], v10 offset:23040
    s_lshl_b32 s68, s98, 1
    s_add_u32 s68, s68, s41
    s_lshl_b32 s59, s99, 1
    s_add_u32 s59, s59, s42
    s_lshl_b32 s59, s59, 7
    s_add_u32 s59, s59, s68
    s_waitcnt lgkmcnt(0)
    s_barrier
    v_mfma_f32_32x32x16_bf16 v[128:143], v[44:47], v[32:35], v[128:143]
    ds_read_b128 v[80:83], v5 offset:57344
    ds_read_b64_tr_b16 v[84:85], v10 offset:24576
    v_mfma_f32_32x32x16_bf16 v[112:127], v[40:43], v[32:35], v[112:127]
    ds_read_b64_tr_b16 v[86:87], v10 offset:25088
    ds_read_b64_tr_b16 v[88:89], v10 offset:32768
    ds_read_b64_tr_b16 v[90:91], v10 offset:33280
    v_mfma_f32_32x32x16_bf16 v[96:111], v[36:39], v[32:35], v[96:111]
    ds_read_b64_tr_b16 v[92:93], v10 offset:40960
    ds_read_b64_tr_b16 v[94:95], v10 offset:41472
    s_lshl_b32 s70, s59, 10
    s_add_u32 s71, s70, 65536
    s_lshl_b32 s68, s59, 11
    s_add_u32 s68, s68, 2097152
    s_add_u32 s69, s68, 131072
    s_waitcnt lgkmcnt(7)
    v_mfma_f32_32x32x16_bf16 v[128:143], v[76:79], v[64:67], v[128:143]
    ds_read_b128 v[32:35], v6 offset:57344
    ds_read_b64_tr_b16 v[36:37], v10 offset:26624
    v_mfma_f32_32x32x16_bf16 v[112:127], v[72:75], v[64:67], v[112:127]
    ds_read_b64_tr_b16 v[38:39], v10 offset:27136
    ds_read_b64_tr_b16 v[40:41], v10 offset:34816
    ds_read_b64_tr_b16 v[42:43], v10 offset:35328
    v_mfma_f32_32x32x16_bf16 v[96:111], v[68:71], v[64:67], v[96:111]
    ds_read_b64_tr_b16 v[44:45], v10 offset:43008
    ds_read_b64_tr_b16 v[46:47], v10 offset:43520
    v_and_b32 v20, 31, v0
    v_lshlrev_b32 v20, 6, v20
    v_lshl_add_u32 v20, v1, 3, v20
    s_lshl_b32 s72, s40, 11
    s_add_u32 s72, s72, 114688
    v_add_u32 v20, s72, v20
    s_waitcnt lgkmcnt(7)
    v_mfma_f32_32x32x16_bf16 v[128:143], v[92:95], v[80:83], v[128:143]
    ds_read_b128 v[64:67], v7 offset:57344
    ds_read_b64_tr_b16 v[68:69], v10 offset:28672
    v_mfma_f32_32x32x16_bf16 v[112:127], v[88:91], v[80:83], v[112:127]
    ds_read_b64_tr_b16 v[70:71], v10 offset:29184
    ds_read_b64_tr_b16 v[72:73], v10 offset:36864
    ds_read_b64_tr_b16 v[74:75], v10 offset:37376
    v_mfma_f32_32x32x16_bf16 v[96:111], v[84:87], v[80:83], v[96:111]
    ds_read_b64_tr_b16 v[76:77], v10 offset:45056
    ds_read_b64_tr_b16 v[78:79], v10 offset:45568
    v_lshlrev_b32 v22, 10, v1
    v_lshl_add_u32 v22, v27, 9, v22
    v_bfe_u32 v23, v0, 2, 2
    v_lshl_add_u32 v22, v23, 6, v22
    s_waitcnt lgkmcnt(7)
    v_mfma_f32_32x32x16_bf16 v[128:143], v[44:47], v[32:35], v[128:143]
    ds_read_b128 v[80:83], v8 offset:57344
    ds_read_b64_tr_b16 v[84:85], v10 offset:30720
    v_mfma_f32_32x32x16_bf16 v[112:127], v[40:43], v[32:35], v[112:127]
    ds_read_b64_tr_b16 v[86:87], v10 offset:31232
    ds_read_b64_tr_b16 v[88:89], v10 offset:38912
    ds_read_b64_tr_b16 v[90:91], v10 offset:39424
    v_mfma_f32_32x32x16_bf16 v[96:111], v[36:39], v[32:35], v[96:111]
    ds_read_b64_tr_b16 v[92:93], v10 offset:47104
    ds_read_b64_tr_b16 v[94:95], v10 offset:47616
    v_and_b32 v23, 3, v0
    v_lshl_add_u32 v22, v23, 3, v22
    v_add_u32 v22, s72, v22
    v_mov_b32 v24, 0x3eb8aa3b
    v_mov_b32 v25, v24
    s_waitcnt lgkmcnt(7)
    v_mfma_f32_32x32x16_bf16 v[128:143], v[76:79], v[64:67], v[128:143]
    v_mfma_f32_32x32x16_bf16 v[112:127], v[72:75], v[64:67], v[112:127]
    v_mfma_f32_32x32x16_bf16 v[96:111], v[68:71], v[64:67], v[96:111]
    s_waitcnt lgkmcnt(0)
    v_mfma_f32_32x32x16_bf16 v[128:143], v[92:95], v[80:83], v[128:143]
    v_mfma_f32_32x32x16_bf16 v[112:127], v[88:91], v[80:83], v[112:127]
    v_mfma_f32_32x32x16_bf16 v[96:111], v[84:87], v[80:83], v[96:111]
    s_nop 9
    v_cvt_pk_bf16_f32 v128, v128, v129
    v_cvt_pk_bf16_f32 v129, v130, v131
    v_cvt_pk_bf16_f32 v130, v132, v133
    v_cvt_pk_bf16_f32 v131, v134, v135
    v_cvt_pk_bf16_f32 v132, v136, v137
    v_cvt_pk_bf16_f32 v133, v138, v139
    v_cvt_pk_bf16_f32 v134, v140, v141
    v_cvt_pk_bf16_f32 v135, v142, v143
    ds_write_b64 v20, v[128:129] offset:0
    ds_write_b64 v20, v[130:131] offset:16
    ds_write_b64 v20, v[132:133] offset:32
    ds_write_b64 v20, v[134:135] offset:48
    v_cvt_pk_bf16_f32 v112, v112, v113
    v_cvt_pk_bf16_f32 v113, v114, v115
    v_cvt_pk_bf16_f32 v114, v116, v117
    v_cvt_pk_bf16_f32 v115, v118, v119
    v_cvt_pk_bf16_f32 v116, v120, v121
    v_cvt_pk_bf16_f32 v117, v122, v123
    v_cvt_pk_bf16_f32 v118, v124, v125
    v_cvt_pk_bf16_f32 v119, v126, v127
    s_waitcnt lgkmcnt(0)
    ds_read_b64_tr_b16 v[128:129], v22 offset:0
    ds_read_b64_tr_b16 v[130:131], v22 offset:256
    ds_read_b64_tr_b16 v[132:133], v22 offset:32
    ds_read_b64_tr_b16 v[134:135], v22 offset:288
    buffer_store_dwordx4 v[112:115], v2, s[32:35], s68 offen sc1
    buffer_store_dwordx4 v[116:119], v2, s[32:35], s69 offen sc1
    s_waitcnt lgkmcnt(0)
    buffer_store_dwordx4 v[128:131], v2, s[32:35], s68 offen offset:1024 sc1
    buffer_store_dwordx4 v[132:135], v2, s[32:35], s69 offen offset:1024 sc1
    v_pk_mul_f32 v[96:97], v[96:97], v[24:25]
    v_pk_mul_f32 v[98:99], v[98:99], v[24:25]
    v_pk_mul_f32 v[100:101], v[100:101], v[24:25]
    v_pk_mul_f32 v[102:103], v[102:103], v[24:25]
    v_pk_mul_f32 v[104:105], v[104:105], v[24:25]
    v_pk_mul_f32 v[106:107], v[106:107], v[24:25]
    v_pk_mul_f32 v[108:109], v[108:109], v[24:25]
    v_pk_mul_f32 v[110:111], v[110:111], v[24:25]
    v_cvt_pk_bf16_f32 v96, v96, v97
    v_cvt_pk_bf16_f32 v97, v98, v99
    v_cvt_pk_bf16_f32 v98, v100, v101
    v_cvt_pk_bf16_f32 v99, v102, v103
    v_cvt_pk_bf16_f32 v100, v104, v105
    v_cvt_pk_bf16_f32 v101, v106, v107
    v_cvt_pk_bf16_f32 v102, v108, v109
    v_cvt_pk_bf16_f32 v103, v110, v111
    buffer_store_dwordx4 v[96:99], v2, s[32:35], s70 offen sc1
    buffer_store_dwordx4 v[100:103], v2, s[32:35], s71 offen sc1
    s_setprio 0
    s_branch p1_join
p1_help:
    s_add_u32 m0, s101, 114688
    s_add_u32 s88, s100, 2
    s_and_b32 s88, s88, 7
    s_mul_i32 s59, s88, 196608
    buffer_load_dwordx4 v30, s[20:23], s59 offen lds
    s_add_u32 m0, s101, 122880
    s_add_u32 s59, s59, 1024
    buffer_load_dwordx4 v30, s[20:23], s59 offen lds
    s_add_u32 m0, s101, 131072
    s_add_u32 s59, s59, 1024
    buffer_load_dwordx4 v30, s[20:23], s59 offen lds
    s_add_u32 m0, s101, 118784
    s_add_u32 s88, s100, 2
    s_and_b32 s88, s88, 7
    s_mul_i32 s59, s88, 196608
    s_add_u32 s59, s59, 98304
    buffer_load_dwordx4 v30, s[20:23], s59 offen lds
    s_add_u32 m0, s101, 126976
    s_add_u32 s59, s59, 1024
    buffer_load_dwordx4 v30, s[20:23], s59 offen lds
    s_add_u32 m0, s101, 135168
    s_add_u32 s59, s59, 1024
    buffer_load_dwordx4 v30, s[20:23], s59 offen lds
    s_mov_b32 s24, s8
    s_and_b32 s25, s9, 0xffff
    s_mov_b32 s26, 0x1c0000
    s_mov_b32 s27, 0x20000
    s_mov_b32 s28, s10
    s_and_b32 s29, s11, 0xffff
    s_mov_b32 s30, 0x1c0000
    s_mov_b32 s31, 0x20000
    s_mov_b32 s36, s14
    s_and_b32 s37, s15, 0xffff
    s_mov_b32 s38, 0x2000000
    s_mov_b32 s39, 0x20000
    s_mov_b32 s76, s72
    s_and_b32 s77, s73, 0xffff
    s_mov_b32 s78, 0x1c0000
    s_mov_b32 s79, 0x20000
    s_mov_b32 s60, s12
    s_and_b32 s61, s13, 0xffff
    s_mov_b32 s62, 0x80000
    s_mov_b32 s63, 0x20000
    s_mov_b32 s64, s74
    s_and_b32 s65, s75, 0xffff
    s_mov_b32 s66, 0x200000
    s_barrier
    s_add_u32 m0, s101, 139264
    s_add_u32 s88, s100, 3
    s_and_b32 s88, s88, 7
    s_mul_i32 s59, s88, 196608
    buffer_load_dwordx4 v30, s[20:23], s59 offen lds
    s_add_u32 m0, s101, 147456
    s_add_u32 s59, s59, 1024
    buffer_load_dwordx4 v30, s[20:23], s59 offen lds
    s_add_u32 m0, s101, 155648
    s_add_u32 s59, s59, 1024
    buffer_load_dwordx4 v30, s[20:23], s59 offen lds
    s_add_u32 m0, s101, 143360
    s_add_u32 s88, s100, 3
    s_and_b32 s88, s88, 7
    s_mul_i32 s59, s88, 196608
    s_add_u32 s59, s59, 98304
    buffer_load_dwordx4 v30, s[20:23], s59 offen lds
    s_add_u32 m0, s101, 151552
    s_add_u32 s59, s59, 1024
    buffer_load_dwordx4 v30, s[20:23], s59 offen lds
    s_add_u32 m0, s101, 159744
    s_add_u32 s59, s59, 1024
    buffer_load_dwordx4 v30, s[20:23], s59 offen lds
    s_mov_b32 s67, 0x20000
    s_bfe_u32 s75, s2, 0x20003
    s_lshl_b32 s43, s3, 2
    s_add_u32 s43, s43, s75
    s_lshr_b32 s44, s2, 5
    s_lshl_b32 s45, s44, 3
    s_add_u32 s45, s45, s40
    s_lshr_b32 s46, s3, 1
    s_lshl_b32 s46, s46, 2
    s_add_u32 s46, s46, s75
    s_and_b32 s47, s3, 1
    s_mul_i32 s47, s47, 7
    s_add_u32 s47, s47, s44
    s_lshl_b32 s49, s43, 17
    s_add_u32 s49, s49, s101
    s_add_u32 s49, s49, 2097152
    s_lshl_b32 s50, s46, 17
    s_add_u32 s50, s50, 23068672
    v_mul_u32_u24 v192, 3584, v29
    v_add_u32 v192, v192, v31
    s_lshl_b32 s74, s47, 8
    v_add_u32 v192, s74, v192
    v_xor_b32 v193, 32, v192
    s_waitcnt vmcnt(6)
    s_barrier
    s_add_u32 m0, s101, 65536
    s_add_u32 s88, s100, 4
    s_and_b32 s88, s88, 7
    s_mul_i32 s59, s88, 196608
    buffer_load_dwordx4 v30, s[20:23], s59 offen lds
    s_add_u32 m0, s101, 73728
    s_add_u32 s59, s59, 1024
    buffer_load_dwordx4 v30, s[20:23], s59 offen lds
    s_add_u32 m0, s101, 81920
    s_add_u32 s59, s59, 1024
    buffer_load_dwordx4 v30, s[20:23], s59 offen lds
    s_add_u32 m0, s101, 69632
    s_add_u32 s88, s100, 4
    s_and_b32 s88, s88, 7
    s_mul_i32 s59, s88, 196608
    s_add_u32 s59, s59, 98304
    buffer_load_dwordx4 v30, s[20:23], s59 offen lds
    s_add_u32 m0, s101, 77824
    s_add_u32 s59, s59, 1024
    buffer_load_dwordx4 v30, s[20:23], s59 offen lds
    s_add_u32 m0, s101, 86016
    s_add_u32 s59, s59, 1024
    buffer_load_dwordx4 v30, s[20:23], s59 offen lds
    s_lshr_b32 s74, s101, 5
    v_add_u32 v29, s74, v20
    v_lshl_add_u32 v194, v29, 10, v31
    s_lshl_b32 s74, s44, 7
    v_add_u32 v194, s74, v194
    s_mul_i32 s51, s43, 229376
    s_lshl_b32 s74, s101, 2
    s_add_u32 s51, s51, s74
    s_add_u32 s51, s51, 6291456
    v_and_b32 v3, 15, v0
    v_lshlrev_b32 v3, 4, v3
    v_lshl_add_u32 v3, v1, 8, v3
    v_add_u32 v3, 132096, v3
    v_add_u32 v206, 131072, v2
    v_mov_b32 v207, 0xdddd
    s_mov_b32 s52, 0xffff
    s_mov_b32 s53, 0xffff
    s_lshl_b32 s74, s41, 13
    v_add_u32 v236, s74, v23
    v_xor_b32 v237, 32, v236
    v_xor_b32 v238, 64, v236
    v_xor_b32 v239, 96, v236
    v_add_u32 v232, 0x10000, v236
    s_waitcnt vmcnt(6)
    s_barrier
    s_add_u32 m0, s101, 90112
    s_add_u32 s88, s100, 5
    s_and_b32 s88, s88, 7
    s_mul_i32 s59, s88, 196608
    buffer_load_dwordx4 v30, s[20:23], s59 offen lds
    s_add_u32 m0, s101, 98304
    s_add_u32 s59, s59, 1024
    buffer_load_dwordx4 v30, s[20:23], s59 offen lds
    s_add_u32 m0, s101, 106496
    s_add_u32 s59, s59, 1024
    buffer_load_dwordx4 v30, s[20:23], s59 offen lds
    s_add_u32 m0, s101, 94208
    s_add_u32 s88, s100, 5
    s_and_b32 s88, s88, 7
    s_mul_i32 s59, s88, 196608
    s_add_u32 s59, s59, 98304
    buffer_load_dwordx4 v30, s[20:23], s59 offen lds
    s_add_u32 m0, s101, 102400
    s_add_u32 s59, s59, 1024
    buffer_load_dwordx4 v30, s[20:23], s59 offen lds
    s_add_u32 m0, s101, 110592
    s_add_u32 s59, s59, 1024
    buffer_load_dwordx4 v30, s[20:23], s59 offen lds
    v_add_u32 v233, 0x10000, v237
    v_add_u32 v234, 0x10000, v238
    v_add_u32 v235, 0x10000, v239
    v_lshl_add_u32 v200, v27, 13, v28
    v_lshl_add_u32 v200, v1, 10, v200
    s_lshl_b32 s74, s48, 14
    s_add_u32 s74, s74, 16384
    v_add_u32 v200, s74, v200
    v_xor_b32 v201, 32, v200
    v_add_u32 v198, 0x10000, v200
    v_add_u32 v199, 0x10000, v201
    v_lshl_add_u32 v204, v1, 9, v28
    s_lshl_b32 s74, s42, 6
    v_xor_b32 v204, s74, v204
    s_lshl_b32 s74, s101, 3
    v_add_u32 v204, s74, v204
    v_xor_b32 v205, 64, v204
    v_add_u32 v202, 0x10000, v204
    v_add_u32 v203, 0x10000, v205
    s_lshl_b32 s54, s46, 2
    s_lshl_b32 s74, s41, 1
    s_add_u32 s54, s54, s74
    s_mul_i32 s54, s54, 112
    s_waitcnt vmcnt(6)
    s_barrier
    s_add_u32 m0, s101, 114688
    s_add_u32 s88, s100, 6
    s_and_b32 s88, s88, 7
    s_mul_i32 s59, s88, 196608
    buffer_load_dwordx4 v30, s[20:23], s59 offen lds
    s_add_u32 m0, s101, 122880
    s_add_u32 s59, s59, 1024
    buffer_load_dwordx4 v30, s[20:23], s59 offen lds
    s_add_u32 m0, s101, 131072
    s_add_u32 s59, s59, 1024
    buffer_load_dwordx4 v30, s[20:23], s59 offen lds
    s_add_u32 m0, s101, 118784
    s_add_u32 s88, s100, 6
    s_and_b32 s88, s88, 7
    s_mul_i32 s59, s88, 196608
    s_add_u32 s59, s59, 98304
    buffer_load_dwordx4 v30, s[20:23], s59 offen lds
    s_add_u32 m0, s101, 126976
    s_add_u32 s59, s59, 1024
    buffer_load_dwordx4 v30, s[20:23], s59 offen lds
    s_add_u32 m0, s101, 135168
    s_add_u32 s59, s59, 1024
    buffer_load_dwordx4 v30, s[20:23], s59 offen lds
    s_lshl_b32 s74, s47, 3
    s_add_u32 s54, s54, s74
    s_and_b32 s74, s40, 6
    s_add_u32 s54, s54, s74
    s_lshl_b32 s54, s54, 10
    s_add_u32 s54, s54, 6291456
    s_add_u32 s55, s54, 114688
    s_lshl_b32 s81, s48, 12
    s_add_u32 s81, s81, s49
    s_lshl_b32 s82, s48, 16
    s_add_u32 s82, s82, s50
    s_mul_i32 s83, s48, 114688
    s_lshl_b32 s84, s48, 17
    s_mul_i32 s85, s48, 114688
    s_add_u32 s85, s85, s51
    s_lshr_b32 s86, s46, 1
    s_mul_i32 s74, s43, 37
    s_lshr_b32 s74, s74, 8
    s_mul_i32 s74, s74, 7
    s_sub_u32 s87, s43, s74
    v_and_b32 v22, 15, v0
    v_lshlrev_b32 v22, 7, v22
    s_lshl_b32 s56, s46, 11
    s_add_u32 s56, s56, 22020096
    s_cmp_eq_u32 s44, 7
    s_cselect_b32 s26, 0, s26
    s_cselect_b32 s30, 0, s30
    s_cselect_b32 s38, 0, s38
    s_waitcnt vmcnt(6)
    s_barrier
    s_add_u32 m0, s101, 139264
    s_add_u32 s88, s100, 7
    s_and_b32 s88, s88, 7
    s_mul_i32 s59, s88, 196608
    buffer_load_dwordx4 v30, s[20:23], s59 offen lds
    s_add_u32 m0, s101, 147456
    s_add_u32 s59, s59, 1024
    buffer_load_dwordx4 v30, s[20:23], s59 offen lds
    s_add_u32 m0, s101, 155648
    s_add_u32 s59, s59, 1024
    buffer_load_dwordx4 v30, s[20:23], s59 offen lds
    s_add_u32 m0, s101, 143360
    s_add_u32 s88, s100, 7
    s_and_b32 s88, s88, 7
    s_mul_i32 s59, s88, 196608
    s_add_u32 s59, s59, 98304
    buffer_load_dwordx4 v30, s[20:23], s59 offen lds
    s_add_u32 m0, s101, 151552
    s_add_u32 s59, s59, 1024
    buffer_load_dwordx4 v30, s[20:23], s59 offen lds
    s_add_u32 m0, s101, 159744
    s_add_u32 s59, s59, 1024
    buffer_load_dwordx4 v30, s[20:23], s59 offen lds
    buffer_load_dword v23, v22, s[32:35], s56 offen sc1
    s_waitcnt vmcnt(7)
    s_barrier
    s_add_u32 m0, s101, 81920
    s_add_u32 s88, s86, 0
    s_and_b32 s88, s88, 7
    s_mul_i32 s59, s88, 229376
    s_add_u32 s59, s59, 0
    buffer_load_dwordx4 v192, s[24:27], s59 offen lds
    s_add_u32 m0, s101, 90112
    s_nop 0
    buffer_load_dwordx4 v193, s[28:31], s59 offen lds
    s_add_u32 m0, s101, 98304
    s_add_u32 s59, s59, 128
    buffer_load_dwordx4 v192, s[24:27], s59 offen lds
    s_add_u32 m0, s101, 106496
    s_nop 0
    buffer_load_dwordx4 v193, s[28:31], s59 offen lds
    s_add_u32 m0, s101, 86016
    s_add_u32 s88, s86, 0
    s_and_b32 s88, s88, 7
    s_mul_i32 s59, s88, 229376
    s_add_u32 s59, s59, 114688
    buffer_load_dwordx4 v192, s[24:27], s59 offen lds
    s_add_u32 m0, s101, 94208
    s_nop 0
    buffer_load_dwordx4 v193, s[28:31], s59 offen lds
    s_add_u32 m0, s101, 102400
    s_add_u32 s59, s59, 128
    buffer_load_dwordx4 v192, s[24:27], s59 offen lds
    s_add_u32 m0, s101, 110592
    s_nop 0
    buffer_load_dwordx4 v193, s[28:31], s59 offen lds
    s_waitcnt vmcnt(9)
    s_barrier
    s_waitcnt vmcnt(8)
    v_cmp_ne_u32 vcc, s58, v23
    s_nop 4
    s_cbranch_vccnz p1_c1_spin
    p1_c1_ret:
    s_lshl_b32 s59, s101, 1
    s_add_u32 m0, s59, 65536
    s_add_u32 s88, s86, 0
    s_and_b32 s88, s88, 7
    s_lshl_b32 s59, s88, 7
    s_add_u32 s59, s59, s50
    buffer_load_dwordx4 v196, s[36:39], s59 offen sc1 lds
    s_add_u32 m0, m0, 1024
    s_nop 0
    buffer_load_dwordx4 v197, s[36:39], s59 offen sc1 lds
    s_lshl_b32 s59, s101, 1
    s_add_u32 m0, s59, 73728
    s_add_u32 s88, s86, 0
    s_and_b32 s88, s88, 7
    s_lshl_b32 s59, s88, 7
    s_add_u32 s59, s59, s50
    s_add_u32 s59, s59, 65536
    buffer_load_dwordx4 v196, s[36:39], s59 offen sc1 lds
    s_add_u32 m0, m0, 1024
    s_nop 0
    buffer_load_dwordx4 v197, s[36:39], s59 offen sc1 lds
    s_lshl_b32 s59, s101, 1
    s_add_u32 m0, s59, 0
    s_add_u32 s88, s86, 1
    s_and_b32 s88, s88, 7
    s_lshl_b32 s59, s88, 7
    s_add_u32 s59, s59, s50
    buffer_load_dwordx4 v196, s[36:39], s59 offen sc1 lds
    s_add_u32 m0, m0, 1024
    s_nop 0
    buffer_load_dwordx4 v197, s[36:39], s59 offen sc1 lds
    s_add_u32 m0, s101, 16384
    s_add_u32 s88, s86, 1
    s_and_b32 s88, s88, 7
    s_mul_i32 s59, s88, 229376
    s_add_u32 s59, s59, 0
    buffer_load_dwordx4 v192, s[24:27], s59 offen lds
    s_add_u32 m0, s101, 24576
    s_nop 0
    buffer_load_dwordx4 v193, s[28:31], s59 offen lds
    s_add_u32 m0, s101, 32768
    s_add_u32 s59, s59, 128
    buffer_load_dwordx4 v192, s[24:27], s59 offen lds
    s_add_u32 m0, s101, 40960
    s_nop 0
    buffer_load_dwordx4 v193, s[28:31], s59 offen lds
    s_lshl_b32 s59, s101, 1
    s_add_u32 m0, s59, 8192
    s_add_u32 s88, s86, 1
    s_and_b32 s88, s88, 7
    s_lshl_b32 s59, s88, 7
    s_add_u32 s59, s59, s50
    s_add_u32 s59, s59, 65536
    buffer_load_dwordx4 v196, s[36:39], s59 offen sc1 lds
    s_add_u32 m0, m0, 1024
    s_nop 0
    buffer_load_dwordx4 v197, s[36:39], s59 offen sc1 lds
    s_add_u32 m0, s101, 20480
    s_add_u32 s88, s86, 1
    s_and_b32 s88, s88, 7
    s_mul_i32 s59, s88, 229376
    s_add_u32 s59, s59, 114688
    buffer_load_dwordx4 v192, s[24:27], s59 offen lds
    s_add_u32 m0, s101, 28672
    s_nop 0
    buffer_load_dwordx4 v193, s[28:31], s59 offen lds
    s_add_u32 m0, s101, 36864
    s_add_u32 s59, s59, 128
    buffer_load_dwordx4 v192, s[24:27], s59 offen lds
    s_add_u32 m0, s101, 45056
    s_nop 0
    buffer_load_dwordx4 v193, s[28:31], s59 offen lds
    s_waitcnt vmcnt(12)
p1_join:
    s_cmp_eq_u32 s44, 7
    s_cselect_b32 s26, 0, s26
    s_cselect_b32 s30, 0, s30
    s_cselect_b32 s38, 0, s38
    v_mov_b32 v12, 0
    v_mov_b32 v13, 0
    v_mov_b32 v14, 0
    v_mov_b32 v15, 0
    v_mov_b32 v16, 0
    v_mov_b32 v17, 0
    v_mov_b32 v18, 0
    v_mov_b32 v19, 0
    v_mov_b32 v20, 0
    v_mov_b32 v21, 0
    v_mov_b32 v22, 0
    v_mov_b32 v23, 0
    v_mov_b32 v24, 0
    v_mov_b32 v25, 0
    v_mov_b32 v26, 0
    v_mov_b32 v27, 0
    s_mov_b32 exec_lo, 0x110000
    s_mov_b32 exec_hi, 0x110000
    v_mov_b32 v12, 0x3f803f80
    v_mov_b32 v13, 0x3f803f80
    v_mov_b32 v14, 0x3f803f80
    v_mov_b32 v15, 0x3f803f80
    v_mov_b32 v16, 0x3f803f80
    v_mov_b32 v17, 0x3f803f80
    v_mov_b32 v18, 0x3f803f80
    v_mov_b32 v19, 0x3f803f80
    v_mov_b32 v20, 0x3f803f80
    v_mov_b32 v21, 0x3f803f80
    v_mov_b32 v22, 0x3f803f80
    v_mov_b32 v23, 0x3f803f80
    v_mov_b32 v24, 0x3f803f80
    v_mov_b32 v25, 0x3f803f80
    v_mov_b32 v26, 0x3f803f80
    v_mov_b32 v27, 0x3f803f80
    s_mov_b64 exec, -1
    v_lshrrev_b32 v30, 1, v0
    v_lshlrev_b32 v30, 7, v30
    v_and_b32 v31, 1, v0
    v_lshl_add_u32 v30, v31, 2, v30
    s_lshr_b32 s56, s43, 1
    s_lshl_b32 s56, s56, 12
    s_add_u32 s56, s56, 22806528
    s_cmp_eq_u32 s40, 7
    s_cselect_b32 s56, s56, 0x7ff00000
    s_waitcnt lgkmcnt(0)
    s_barrier
    ds_read_b128 v[104:107], v232 offset:0
    ds_read_b128 v[108:111], v232 offset:4096
    ds_read_b64_tr_b16 v[96:97], v198 offset:0
    ds_read_b64_tr_b16 v[98:99], v198 offset:512
    ds_read_b64_tr_b16 v[100:101], v199 offset:0
    ds_read_b64_tr_b16 v[102:103], v199 offset:512
    s_waitcnt lgkmcnt(0)
    v_mfma_f32_32x32x16_bf16 v[128:143], v[96:99], v[104:107], 0
    ds_read_b128 v[120:123], v233 offset:0
    v_mfma_f32_32x32x16_bf16 v[144:159], v[100:103], v[104:107], 0
    ds_read_b128 v[124:127], v233 offset:4096
    ds_read_b64_tr_b16 v[112:113], v198 offset:2048
    v_mfma_f32_32x32x16_bf16 v[160:175], v[96:99], v[108:111], 0
    ds_read_b64_tr_b16 v[114:115], v198 offset:2560
    v_mfma_f32_32x32x16_bf16 v[176:191], v[100:103], v[108:111], 0
    ds_read_b64_tr_b16 v[116:117], v199 offset:2048
    ds_read_b64_tr_b16 v[118:119], v199 offset:2560
    s_waitcnt lgkmcnt(0)
    v_mfma_f32_32x32x16_bf16 v[128:143], v[112:115], v[120:123], v[128:143]
    ds_read_b128 v[104:107], v234 offset:0
    v_mfma_f32_32x32x16_bf16 v[144:159], v[116:119], v[120:123], v[144:159]
    ds_read_b128 v[108:111], v234 offset:4096
    ds_read_b64_tr_b16 v[96:97], v198 offset:4096
    v_mfma_f32_32x32x16_bf16 v[160:175], v[112:115], v[124:127], v[160:175]
    ds_read_b64_tr_b16 v[98:99], v198 offset:4608
    v_mfma_f32_32x32x16_bf16 v[176:191], v[116:119], v[124:127], v[176:191]
    ds_read_b64_tr_b16 v[100:101], v199 offset:4096
    ds_read_b64_tr_b16 v[102:103], v199 offset:4608
    s_waitcnt vmcnt(0)
    s_lshl_b32 s59, s99, 1
    s_add_u32 s59, s59, s42
    s_lshl_b32 s59, s59, 5
    s_add_u32 s59, s59, s98
    s_lshl_b32 s59, s59, 5
    s_add_u32 s59, s59, s41
    s_lshl_b32 s59, s59, 2
    s_add_u32 s59, s59, 22806528
    s_cmp_lt_u32 s40, 4
    s_cselect_b32 s59, s59, 0x7ffffff0
    v_mov_b32 v28, s58
    v_mov_b32 v29, 0
    s_mov_b64 exec, 1
    buffer_store_dword v28, v29, s[32:35], s59 offen sc1
    s_mov_b64 exec, -1
    s_waitcnt lgkmcnt(0)
    v_mfma_f32_32x32x16_bf16 v[128:143], v[96:99], v[104:107], v[128:143]
    ds_read_b128 v[120:123], v235 offset:0
    v_mfma_f32_32x32x16_bf16 v[144:159], v[100:103], v[104:107], v[144:159]
    ds_read_b128 v[124:127], v235 offset:4096
    ds_read_b64_tr_b16 v[112:113], v198 offset:6144
    v_mfma_f32_32x32x16_bf16 v[160:175], v[96:99], v[108:111], v[160:175]
    ds_read_b64_tr_b16 v[114:115], v198 offset:6656
    v_mfma_f32_32x32x16_bf16 v[176:191], v[100:103], v[108:111], v[176:191]
    ds_read_b64_tr_b16 v[116:117], v199 offset:6144
    ds_read_b64_tr_b16 v[118:119], v199 offset:6656
    s_waitcnt vmcnt(2) lgkmcnt(0)
    s_barrier
    v_mfma_f32_32x32x16_bf16 v[128:143], v[112:115], v[120:123], v[128:143]
    ds_read_b128 v[104:107], v236 offset:0
    ds_read_b128 v[108:111], v236 offset:4096
    v_mfma_f32_32x32x16_bf16 v[144:159], v[116:119], v[120:123], v[144:159]
    ds_read_b64_tr_b16 v[96:97], v200 offset:0
    ds_read_b64_tr_b16 v[98:99], v200 offset:512
    v_mfma_f32_32x32x16_bf16 v[160:175], v[112:115], v[124:127], v[160:175]
    ds_read_b64_tr_b16 v[100:101], v201 offset:0
    ds_read_b64_tr_b16 v[102:103], v201 offset:512
    v_mfma_f32_32x32x16_bf16 v[176:191], v[116:119], v[124:127], v[176:191]
    s_lshl_b32 s59, s80, 1
    s_add_u32 m0, s59, 65536
    s_add_u32 s88, s86, 2
    s_and_b32 s88, s88, 7
    s_lshl_b32 s59, s88, 7
    s_add_u32 s59, s59, s82
    buffer_load_dwordx4 v196, s[36:39], s59 offen sc1 lds
    s_add_u32 m0, m0, 1024
    s_nop 0
    buffer_load_dwordx4 v197, s[36:39], s59 offen sc1 lds
    s_add_u32 m0, s80, 81920
    s_add_u32 s88, s86, 2
    s_and_b32 s88, s88, 7
    s_mul_i32 s59, s88, 229376
    s_add_u32 s59, s59, s83
    buffer_load_dwordx4 v192, s[24:27], s59 offen lds
    s_waitcnt lgkmcnt(0)
    v_mfma_f32_32x32x16_bf16 v[128:143], v[96:99], v[104:107], v[128:143]
    ds_read_b128 v[120:123], v237 offset:0
    ds_read_b128 v[124:127], v237 offset:4096
    v_mfma_f32_32x32x16_bf16 v[144:159], v[100:103], v[104:107], v[144:159]
    ds_read_b64_tr_b16 v[112:113], v200 offset:2048
    ds_read_b64_tr_b16 v[114:115], v200 offset:2560
    v_mfma_f32_32x32x16_bf16 v[160:175], v[96:99], v[108:111], v[160:175]
    ds_read_b64_tr_b16 v[116:117], v201 offset:2048
    ds_read_b64_tr_b16 v[118:119], v201 offset:2560
    v_mfma_f32_32x32x16_bf16 v[176:191], v[100:103], v[108:111], v[176:191]
    s_add_u32 m0, s80, 90112
    s_nop 0
    buffer_load_dwordx4 v193, s[28:31], s59 offen lds
    s_add_u32 m0, s80, 98304
    s_add_u32 s59, s59, 128
    buffer_load_dwordx4 v192, s[24:27], s59 offen lds
    s_add_u32 m0, s80, 106496
    s_nop 0
    buffer_load_dwordx4 v193, s[28:31], s59 offen lds
    s_waitcnt lgkmcnt(0)
    v_mfma_f32_32x32x16_bf16 v[128:143], v[112:115], v[120:123], v[128:143]
    ds_read_b128 v[104:107], v238 offset:0
    v_mfma_f32_32x32x16_bf16 v[144:159], v[116:119], v[120:123], v[144:159]
    ds_read_b128 v[108:111], v238 offset:4096
    ds_read_b64_tr_b16 v[96:97], v200 offset:4096
    v_mfma_f32_32x32x16_bf16 v[160:175], v[112:115], v[124:127], v[160:175]
    ds_read_b64_tr_b16 v[98:99], v200 offset:4608
    v_mfma_f32_32x32x16_bf16 v[176:191], v[116:119], v[124:127], v[176:191]
    ds_read_b64_tr_b16 v[100:101], v201 offset:4096
    ds_read_b64_tr_b16 v[102:103], v201 offset:4608
    s_waitcnt lgkmcnt(0)
    v_mfma_f32_32x32x16_bf16 v[128:143], v[96:99], v[104:107], v[128:143]
    ds_read_b128 v[120:123], v239 offset:0
    v_mfma_f32_32x32x16_bf16 v[144:159], v[100:103], v[104:107], v[144:159]
    ds_read_b128 v[124:127], v239 offset:4096
    ds_read_b64_tr_b16 v[112:113], v200 offset:6144
    v_mfma_f32_32x32x16_bf16 v[160:175], v[96:99], v[108:111], v[160:175]
    ds_read_b64_tr_b16 v[114:115], v200 offset:6656
    ds_read_b64_tr_b16 v[116:117], v201 offset:6144
    v_mfma_f32_32x32x16_bf16 v[176:191], v[100:103], v[108:111], v[176:191]
    ds_read_b64_tr_b16 v[118:119], v201 offset:6656
    buffer_load_dword v31, v30, s[32:35], s56 offen sc1
    s_cmp_eq_u32 s40, 7
    s_cbranch_scc0 m_c2_ret
    s_waitcnt vmcnt(0)
    v_cmp_ne_u32 vcc, s58, v31
    s_nop 4
    s_cbranch_vccnz m_c2_spin
    m_c2_ret:
    s_waitcnt vmcnt(1) lgkmcnt(0)
    s_barrier
    s_lshl_b32 s59, s43, 6
    s_add_u32 s59, s59, s45
    s_lshl_b32 s59, s59, 10
    buffer_load_dwordx4 v[4:7], v2, s[32:35], s59 offen sc1
    s_add_u32 m0, s80, 131072
    s_add_u32 s59, s81, 0
    buffer_load_dwordx4 v2, s[32:35], s59 offen sc1 lds
    s_add_u32 m0, s80, 139264
    s_add_u32 s59, s81, 8192
    buffer_load_dwordx4 v2, s[32:35], s59 offen sc1 lds
    v_mfma_f32_32x32x16_bf16 v[128:143], v[112:115], v[120:123], v[128:143]
    ds_read_b128 v[104:107], v232 offset:0
    ds_read_b128 v[108:111], v232 offset:4096
    v_mfma_f32_32x32x16_bf16 v[144:159], v[116:119], v[120:123], v[144:159]
    ds_read_b64_tr_b16 v[96:97], v198 offset:0
    ds_read_b64_tr_b16 v[98:99], v198 offset:512
    v_mfma_f32_32x32x16_bf16 v[160:175], v[112:115], v[124:127], v[160:175]
    ds_read_b64_tr_b16 v[100:101], v199 offset:0
    ds_read_b64_tr_b16 v[102:103], v199 offset:512
    v_mfma_f32_32x32x16_bf16 v[176:191], v[116:119], v[124:127], v[176:191]
    s_lshl_b32 s59, s80, 1
    s_add_u32 m0, s59, 0
    s_add_u32 s88, s86, 3
    s_and_b32 s88, s88, 7
    s_lshl_b32 s59, s88, 7
    s_add_u32 s59, s59, s82
    buffer_load_dwordx4 v196, s[36:39], s59 offen sc1 lds
    s_add_u32 m0, m0, 1024
    s_nop 0
    buffer_load_dwordx4 v197, s[36:39], s59 offen sc1 lds
    s_add_u32 m0, s80, 16384
    s_add_u32 s88, s86, 3
    s_and_b32 s88, s88, 7
    s_mul_i32 s59, s88, 229376
    s_add_u32 s59, s59, s83
    buffer_load_dwordx4 v192, s[24:27], s59 offen lds
    s_waitcnt lgkmcnt(0)
    v_mfma_f32_32x32x16_bf16 v[128:143], v[96:99], v[104:107], v[128:143]
    ds_read_b128 v[120:123], v233 offset:0
    ds_read_b128 v[124:127], v233 offset:4096
    v_mfma_f32_32x32x16_bf16 v[144:159], v[100:103], v[104:107], v[144:159]
    ds_read_b64_tr_b16 v[112:113], v198 offset:2048
    ds_read_b64_tr_b16 v[114:115], v198 offset:2560
    v_mfma_f32_32x32x16_bf16 v[160:175], v[96:99], v[108:111], v[160:175]
    ds_read_b64_tr_b16 v[116:117], v199 offset:2048
    ds_read_b64_tr_b16 v[118:119], v199 offset:2560
    v_mfma_f32_32x32x16_bf16 v[176:191], v[100:103], v[108:111], v[176:191]
    s_add_u32 m0, s80, 24576
    s_nop 0
    buffer_load_dwordx4 v193, s[28:31], s59 offen lds
    s_add_u32 m0, s80, 32768
    s_add_u32 s59, s59, 128
    buffer_load_dwordx4 v192, s[24:27], s59 offen lds
    s_add_u32 m0, s80, 40960
    s_nop 0
    buffer_load_dwordx4 v193, s[28:31], s59 offen lds
    s_waitcnt lgkmcnt(0)
    v_mfma_f32_32x32x16_bf16 v[128:143], v[112:115], v[120:123], v[128:143]
    ds_read_b128 v[104:107], v234 offset:0
    v_mfma_f32_32x32x16_bf16 v[144:159], v[116:119], v[120:123], v[144:159]
    ds_read_b128 v[108:111], v234 offset:4096
    ds_read_b64_tr_b16 v[96:97], v198 offset:4096
    v_mfma_f32_32x32x16_bf16 v[160:175], v[112:115], v[124:127], v[160:175]
    ds_read_b64_tr_b16 v[98:99], v198 offset:4608
    v_mfma_f32_32x32x16_bf16 v[176:191], v[116:119], v[124:127], v[176:191]
    ds_read_b64_tr_b16 v[100:101], v199 offset:4096
    ds_read_b64_tr_b16 v[102:103], v199 offset:4608
    s_waitcnt lgkmcnt(0)
    v_mfma_f32_32x32x16_bf16 v[128:143], v[96:99], v[104:107], v[128:143]
    ds_read_b128 v[120:123], v235 offset:0
    v_mfma_f32_32x32x16_bf16 v[144:159], v[100:103], v[104:107], v[144:159]
    ds_read_b128 v[124:127], v235 offset:4096
    ds_read_b64_tr_b16 v[112:113], v198 offset:6144
    v_mfma_f32_32x32x16_bf16 v[160:175], v[96:99], v[108:111], v[160:175]
    ds_read_b64_tr_b16 v[114:115], v198 offset:6656
    v_mfma_f32_32x32x16_bf16 v[176:191], v[100:103], v[108:111], v[176:191]
    ds_read_b64_tr_b16 v[116:117], v199 offset:6144
    ds_read_b64_tr_b16 v[118:119], v199 offset:6656
    s_waitcnt vmcnt(7)
    s_barrier
    ds_read_b128 v[8:11], v206
    s_mov_b64 exec, s[52:53]
    ds_read_b128 v[12:15], v3
    ds_read_b128 v[16:19], v3 offset:512
    s_mov_b64 exec, -1
    s_waitcnt lgkmcnt(2)
    v_mfma_f32_32x32x16_bf16 v[48:63], v[8:11], v[4:7], 0
    v_mov_b32 v80, 0
    v_mov_b32 v81, 0
    v_mov_b32 v82, 0
    v_mov_b32 v83, 0
    v_mov_b32 v84, 0
    v_mov_b32 v85, 0
    v_mov_b32 v86, 0
    v_mov_b32 v87, 0
    v_mov_b32 v88, 0
    v_mov_b32 v89, 0
    v_mov_b32 v90, 0
    v_mov_b32 v91, 0
    v_mov_b32 v92, 0
    v_mov_b32 v93, 0
    v_mov_b32 v94, 0
    v_mov_b32 v95, 0
    v_max3_f32 v28, v48, v49, v50
    v_max_f32 v28, v28, v51
    v_max3_f32 v28, v28, v52, v53
    v_max3_f32 v28, v28, v54, v55
    v_max3_f32 v28, v28, v56, v57
    v_max3_f32 v28, v28, v58, v59
    v_max3_f32 v28, v28, v60, v61
    v_max3_f32 v28, v28, v62, v63
    v_add_f32 v28, 0x42c80000, v28
    v_mov_b32 v29, v28
    s_nop 1
    v_permlane32_swap_b32 v28, v29
    v_max_f32 v28, v28, v29
    v_sub_f32 v32, 0, v28
    v_sub_f32 v33, 0, v28
    v_sub_f32 v34, 0, v28
    v_sub_f32 v35, 0, v28
    v_sub_f32 v36, 0, v28
    v_sub_f32 v37, 0, v28
    v_sub_f32 v38, 0, v28
    v_sub_f32 v39, 0, v28
    v_sub_f32 v40, 0, v28
    v_sub_f32 v41, 0, v28
    v_sub_f32 v42, 0, v28
    v_sub_f32 v43, 0, v28
    v_sub_f32 v44, 0, v28
    v_sub_f32 v45, 0, v28
    v_sub_f32 v46, 0, v28
    v_sub_f32 v47, 0, v28
    s_nop 1
    v_mfma_f32_32x32x16_bf16 v[48:63], v[8:11], v[4:7], v[32:47]
    ds_read_b128 v[8:11], v206 offset:2048
    s_nop 8
    s_waitcnt vmcnt(0) lgkmcnt(0)
    s_barrier
    s_setprio 3
    v_exp_f32 v48, v48
    s_mov_b64 exec, s[52:53]
    ds_read_b128 v[20:23], v3 offset:2048
    ds_read_b128 v[24:27], v3 offset:2560
    s_mov_b64 exec, -1
    ds_read_b128 v[104:107], v236 offset:0
    s_lshl_b32 s59, s80, 1
    s_add_u32 m0, s59, 65536
    s_add_u32 s88, s86, 4
    s_and_b32 s88, s88, 7
    s_lshl_b32 s59, s88, 7
    s_add_u32 s59, s59, s82
    buffer_load_dwordx4 v196, s[36:39], s59 offen sc1 lds
    v_exp_f32 v49, v49
    v_exp_f32 v50, v50
    v_exp_f32 v51, v51
    v_mfma_f32_32x32x16_bf16 v[128:143], v[112:115], v[120:123], v[128:143]
    ds_read_b128 v[108:111], v236 offset:4096
    v_exp_f32 v52, v52
    v_exp_f32 v53, v53
    v_mfma_f32_32x32x16_bf16 v[64:79], v[8:11], v[4:7], v[32:47]
    ds_read_b128 v[8:11], v206 offset:4096
    ds_read_b64_tr_b16 v[96:97], v200 offset:0
    s_add_u32 m0, m0, 1024
    s_nop 0
    buffer_load_dwordx4 v197, s[36:39], s59 offen sc1 lds
    v_exp_f32 v54, v54
    v_exp_f32 v55, v55
    v_mfma_f32_32x32x16_bf16 v[144:159], v[116:119], v[120:123], v[144:159]
    ds_read_b64_tr_b16 v[98:99], v200 offset:512
    v_exp_f32 v56, v56
    v_exp_f32 v57, v57
    v_exp_f32 v58, v58
    v_mfma_f32_32x32x16_bf16 v[160:175], v[112:115], v[124:127], v[160:175]
    ds_read_b64_tr_b16 v[100:101], v201 offset:0
    s_add_u32 m0, s80, 81920
    s_add_u32 s88, s86, 4
    s_and_b32 s88, s88, 7
    s_mul_i32 s59, s88, 229376
    s_add_u32 s59, s59, s83
    buffer_load_dwordx4 v192, s[24:27], s59 offen lds
    v_exp_f32 v59, v59
    v_exp_f32 v60, v60
    v_smfmac_f32_32x32x32_bf16 v[80:95], v[12:15], v[48:55], v207
    ds_read_b64_tr_b16 v[102:103], v201 offset:512
    v_exp_f32 v61, v61
    v_exp_f32 v62, v62
    v_mfma_f32_32x32x16_bf16 v[176:191], v[116:119], v[124:127], v[176:191]
    v_exp_f32 v63, v63
    s_waitcnt lgkmcnt(0)
    v_exp_f32 v64, v64
    v_smfmac_f32_32x32x32_bf16 v[80:95], v[16:19], v[56:63], v207
    s_mov_b64 exec, s[52:53]
    ds_read_b128 v[12:15], v3 offset:4096
    ds_read_b128 v[16:19], v3 offset:4608
    s_mov_b64 exec, -1
    ds_read_b128 v[120:123], v237 offset:0
    s_add_u32 m0, s80, 90112
    s_nop 0
    buffer_load_dwordx4 v193, s[28:31], s59 offen lds
    v_exp_f32 v65, v65
    v_exp_f32 v66, v66
    v_exp_f32 v67, v67
    v_mfma_f32_32x32x16_bf16 v[128:143], v[96:99], v[104:107], v[128:143]
    ds_read_b128 v[124:127], v237 offset:4096
    v_exp_f32 v68, v68
    v_exp_f32 v69, v69
    v_mfma_f32_32x32x16_bf16 v[48:63], v[8:11], v[4:7], v[32:47]
    ds_read_b128 v[8:11], v206 offset:6144
    ds_read_b64_tr_b16 v[112:113], v200 offset:2048
    v_exp_f32 v70, v70
    v_exp_f32 v71, v71
    s_setprio 2
    v_mfma_f32_32x32x16_bf16 v[144:159], v[100:103], v[104:107], v[144:159]
    ds_read_b64_tr_b16 v[114:115], v200 offset:2560
    s_add_u32 m0, s80, 98304
    s_add_u32 s59, s59, 128
    buffer_load_dwordx4 v192, s[24:27], s59 offen lds
    v_exp_f32 v72, v72
    v_exp_f32 v73, v73
    v_exp_f32 v74, v74
    v_mfma_f32_32x32x16_bf16 v[160:175], v[96:99], v[108:111], v[160:175]
    ds_read_b64_tr_b16 v[116:117], v201 offset:2048
    v_exp_f32 v75, v75
    v_exp_f32 v76, v76
    v_smfmac_f32_32x32x32_bf16 v[80:95], v[20:23], v[64:71], v207
    ds_read_b64_tr_b16 v[118:119], v201 offset:2560
    v_exp_f32 v77, v77
    v_exp_f32 v78, v78
    v_mfma_f32_32x32x16_bf16 v[176:191], v[100:103], v[108:111], v[176:191]
    v_exp_f32 v79, v79
    s_waitcnt lgkmcnt(0)
    v_exp_f32 v48, v48
    v_smfmac_f32_32x32x32_bf16 v[80:95], v[24:27], v[72:79], v207
    s_mov_b64 exec, s[52:53]
    ds_read_b128 v[20:23], v3 offset:6144
    ds_read_b128 v[24:27], v3 offset:6656
    s_mov_b64 exec, -1
    ds_read_b128 v[104:107], v238 offset:0
    s_add_u32 m0, s80, 106496
    s_nop 0
    buffer_load_dwordx4 v193, s[28:31], s59 offen lds
    v_exp_f32 v49, v49
    v_exp_f32 v50, v50
    v_exp_f32 v51, v51
    v_mfma_f32_32x32x16_bf16 v[128:143], v[112:115], v[120:123], v[128:143]
    ds_read_b128 v[108:111], v238 offset:4096
    v_exp_f32 v52, v52
    v_exp_f32 v53, v53
    v_mfma_f32_32x32x16_bf16 v[64:79], v[8:11], v[4:7], v[32:47]
    ds_read_b128 v[8:11], v206 offset:8192
    ds_read_b64_tr_b16 v[96:97], v200 offset:4096
    v_exp_f32 v54, v54
    v_exp_f32 v55, v55
    s_setprio 1
    v_mfma_f32_32x32x16_bf16 v[144:159], v[116:119], v[120:123], v[144:159]
    ds_read_b64_tr_b16 v[98:99], v200 offset:4608
    s_add_u32 m0, s80, 147456
    s_add_u32 s59, s81, 16384
    buffer_load_dwordx4 v2, s[32:35], s59 offen sc1 lds
    v_exp_f32 v56, v56
    v_exp_f32 v57, v57
    v_exp_f32 v58, v58
    v_mfma_f32_32x32x16_bf16 v[160:175], v[112:115], v[124:127], v[160:175]
    ds_read_b64_tr_b16 v[100:101], v201 offset:4096
    v_exp_f32 v59, v59
    v_exp_f32 v60, v60
    v_smfmac_f32_32x32x32_bf16 v[80:95], v[12:15], v[48:55], v207
    ds_read_b64_tr_b16 v[102:103], v201 offset:4608
    v_exp_f32 v61, v61
    v_exp_f32 v62, v62
    v_mfma_f32_32x32x16_bf16 v[176:191], v[116:119], v[124:127], v[176:191]
    v_exp_f32 v63, v63
    s_waitcnt lgkmcnt(0)
    v_exp_f32 v64, v64
    v_smfmac_f32_32x32x32_bf16 v[80:95], v[16:19], v[56:63], v207
    s_mov_b64 exec, s[52:53]
    ds_read_b128 v[12:15], v3 offset:8192
    ds_read_b128 v[16:19], v3 offset:8704
    s_mov_b64 exec, -1
    ds_read_b128 v[120:123], v239 offset:0
    v_exp_f32 v65, v65
    v_exp_f32 v66, v66
    v_exp_f32 v67, v67
    v_mfma_f32_32x32x16_bf16 v[128:143], v[96:99], v[104:107], v[128:143]
    ds_read_b128 v[124:127], v239 offset:4096
    v_exp_f32 v68, v68
    v_exp_f32 v69, v69
    v_mfma_f32_32x32x16_bf16 v[48:63], v[8:11], v[4:7], v[32:47]
    ds_read_b128 v[8:11], v206 offset:10240
    ds_read_b64_tr_b16 v[112:113], v200 offset:6144
    v_exp_f32 v70, v70
    v_exp_f32 v71, v71
    s_setprio 0
    v_mfma_f32_32x32x16_bf16 v[144:159], v[100:103], v[104:107], v[144:159]
    ds_read_b64_tr_b16 v[114:115], v200 offset:6656
    v_exp_f32 v72, v72
    v_exp_f32 v73, v73
    v_exp_f32 v74, v74
    v_mfma_f32_32x32x16_bf16 v[160:175], v[96:99], v[108:111], v[160:175]
    ds_read_b64_tr_b16 v[116:117], v201 offset:6144
    v_exp_f32 v75, v75
    v_exp_f32 v76, v76
    v_smfmac_f32_32x32x32_bf16 v[80:95], v[20:23], v[64:71], v207
    ds_read_b64_tr_b16 v[118:119], v201 offset:6656
    v_exp_f32 v77, v77
    v_exp_f32 v78, v78
    v_mfma_f32_32x32x16_bf16 v[176:191], v[100:103], v[108:111], v[176:191]
    v_exp_f32 v79, v79
    s_waitcnt vmcnt(0) lgkmcnt(0)
    s_barrier
    s_setprio 3
    v_exp_f32 v48, v48
    v_smfmac_f32_32x32x32_bf16 v[80:95], v[24:27], v[72:79], v207
    s_mov_b64 exec, s[52:53]
    ds_read_b128 v[20:23], v3 offset:10240
    ds_read_b128 v[24:27], v3 offset:10752
    s_mov_b64 exec, -1
    ds_read_b128 v[104:107], v232 offset:0
    s_lshl_b32 s59, s80, 1
    s_add_u32 m0, s59, 0
    s_add_u32 s88, s86, 5
    s_and_b32 s88, s88, 7
    s_lshl_b32 s59, s88, 7
    s_add_u32 s59, s59, s82
    buffer_load_dwordx4 v196, s[36:39], s59 offen sc1 lds
    v_exp_f32 v49, v49
    v_exp_f32 v50, v50
    v_exp_f32 v51, v51
    v_mfma_f32_32x32x16_bf16 v[128:143], v[112:115], v[120:123], v[128:143]
    ds_read_b128 v[108:111], v232 offset:4096
    v_exp_f32 v52, v52
    v_exp_f32 v53, v53
    v_mfma_f32_32x32x16_bf16 v[64:79], v[8:11], v[4:7], v[32:47]
    ds_read_b128 v[8:11], v206 offset:12288
    ds_read_b64_tr_b16 v[96:97], v198 offset:0
    s_add_u32 m0, m0, 1024
    s_nop 0
    buffer_load_dwordx4 v197, s[36:39], s59 offen sc1 lds
    v_exp_f32 v54, v54
    v_exp_f32 v55, v55
    v_mfma_f32_32x32x16_bf16 v[144:159], v[116:119], v[120:123], v[144:159]
    ds_read_b64_tr_b16 v[98:99], v198 offset:512
    v_exp_f32 v56, v56
    v_exp_f32 v57, v57
    v_exp_f32 v58, v58
    v_mfma_f32_32x32x16_bf16 v[160:175], v[112:115], v[124:127], v[160:175]
    ds_read_b64_tr_b16 v[100:101], v199 offset:0
    s_add_u32 m0, s80, 16384
    s_add_u32 s88, s86, 5
    s_and_b32 s88, s88, 7
    s_mul_i32 s59, s88, 229376
    s_add_u32 s59, s59, s83
    buffer_load_dwordx4 v192, s[24:27], s59 offen lds
    v_exp_f32 v59, v59
    v_exp_f32 v60, v60
    v_smfmac_f32_32x32x32_bf16 v[80:95], v[12:15], v[48:55], v207
    ds_read_b64_tr_b16 v[102:103], v199 offset:512
    v_exp_f32 v61, v61
    v_exp_f32 v62, v62
    v_mfma_f32_32x32x16_bf16 v[176:191], v[116:119], v[124:127], v[176:191]
    v_exp_f32 v63, v63
    s_waitcnt lgkmcnt(0)
    v_exp_f32 v64, v64
    v_smfmac_f32_32x32x32_bf16 v[80:95], v[16:19], v[56:63], v207
    s_mov_b64 exec, s[52:53]
    ds_read_b128 v[12:15], v3 offset:12288
    ds_read_b128 v[16:19], v3 offset:12800
    s_mov_b64 exec, -1
    ds_read_b128 v[120:123], v233 offset:0
    s_add_u32 m0, s80, 24576
    s_nop 0
    buffer_load_dwordx4 v193, s[28:31], s59 offen lds
    v_exp_f32 v65, v65
    v_exp_f32 v66, v66
    v_exp_f32 v67, v67
    v_mfma_f32_32x32x16_bf16 v[128:143], v[96:99], v[104:107], v[128:143]
    ds_read_b128 v[124:127], v233 offset:4096
    v_exp_f32 v68, v68
    v_exp_f32 v69, v69
    v_mfma_f32_32x32x16_bf16 v[48:63], v[8:11], v[4:7], v[32:47]
    ds_read_b128 v[8:11], v206 offset:14336
    ds_read_b64_tr_b16 v[112:113], v198 offset:2048
    v_exp_f32 v70, v70
    v_exp_f32 v71, v71
    s_setprio 2
    v_mfma_f32_32x32x16_bf16 v[144:159], v[100:103], v[104:107], v[144:159]
    ds_read_b64_tr_b16 v[114:115], v198 offset:2560
    s_add_u32 m0, s80, 32768
    s_add_u32 s59, s59, 128
    buffer_load_dwordx4 v192, s[24:27], s59 offen lds
    v_exp_f32 v72, v72
    v_exp_f32 v73, v73
    v_exp_f32 v74, v74
    v_mfma_f32_32x32x16_bf16 v[160:175], v[96:99], v[108:111], v[160:175]
    ds_read_b64_tr_b16 v[116:117], v199 offset:2048
    v_exp_f32 v75, v75
    v_exp_f32 v76, v76
    v_smfmac_f32_32x32x32_bf16 v[80:95], v[20:23], v[64:71], v207
    ds_read_b64_tr_b16 v[118:119], v199 offset:2560
    v_exp_f32 v77, v77
    v_exp_f32 v78, v78
    v_mfma_f32_32x32x16_bf16 v[176:191], v[100:103], v[108:111], v[176:191]
    v_exp_f32 v79, v79
    s_waitcnt lgkmcnt(0)
    v_exp_f32 v48, v48
    v_smfmac_f32_32x32x32_bf16 v[80:95], v[24:27], v[72:79], v207
    s_mov_b64 exec, s[52:53]
    ds_read_b128 v[20:23], v3 offset:14336
    ds_read_b128 v[24:27], v3 offset:14848
    s_mov_b64 exec, -1
    ds_read_b128 v[104:107], v234 offset:0
    s_add_u32 m0, s80, 40960
    s_nop 0
    buffer_load_dwordx4 v193, s[28:31], s59 offen lds
    v_exp_f32 v49, v49
    v_exp_f32 v50, v50
    v_exp_f32 v51, v51
    v_mfma_f32_32x32x16_bf16 v[128:143], v[112:115], v[120:123], v[128:143]
    ds_read_b128 v[108:111], v234 offset:4096
    v_exp_f32 v52, v52
    v_exp_f32 v53, v53
    v_mfma_f32_32x32x16_bf16 v[64:79], v[8:11], v[4:7], v[32:47]
    ds_read_b128 v[8:11], v206 offset:16384
    ds_read_b64_tr_b16 v[96:97], v198 offset:4096
    v_exp_f32 v54, v54
    v_exp_f32 v55, v55
    s_setprio 1
    v_mfma_f32_32x32x16_bf16 v[144:159], v[116:119], v[120:123], v[144:159]
    ds_read_b64_tr_b16 v[98:99], v198 offset:4608
    s_add_u32 m0, s80, 131072
    s_add_u32 s59, s81, 24576
    buffer_load_dwordx4 v2, s[32:35], s59 offen sc1 lds
    v_exp_f32 v56, v56
    v_exp_f32 v57, v57
    v_exp_f32 v58, v58
    v_mfma_f32_32x32x16_bf16 v[160:175], v[112:115], v[124:127], v[160:175]
    ds_read_b64_tr_b16 v[100:101], v199 offset:4096
    v_exp_f32 v59, v59
    v_exp_f32 v60, v60
    v_smfmac_f32_32x32x32_bf16 v[80:95], v[12:15], v[48:55], v207
    ds_read_b64_tr_b16 v[102:103], v199 offset:4608
    v_exp_f32 v61, v61
    v_exp_f32 v62, v62
    v_mfma_f32_32x32x16_bf16 v[176:191], v[116:119], v[124:127], v[176:191]
    v_exp_f32 v63, v63
    s_waitcnt lgkmcnt(0)
    v_exp_f32 v64, v64
    v_smfmac_f32_32x32x32_bf16 v[80:95], v[16:19], v[56:63], v207
    s_mov_b64 exec, s[52:53]
    ds_read_b128 v[12:15], v3 offset:16384
    ds_read_b128 v[16:19], v3 offset:16896
    s_mov_b64 exec, -1
    ds_read_b128 v[120:123], v235 offset:0
    v_exp_f32 v65, v65
    v_exp_f32 v66, v66
    v_exp_f32 v67, v67
    v_mfma_f32_32x32x16_bf16 v[128:143], v[96:99], v[104:107], v[128:143]
    ds_read_b128 v[124:127], v235 offset:4096
    v_exp_f32 v68, v68
    v_exp_f32 v69, v69
    v_mfma_f32_32x32x16_bf16 v[48:63], v[8:11], v[4:7], v[32:47]
    ds_read_b128 v[8:11], v206 offset:18432
    ds_read_b64_tr_b16 v[112:113], v198 offset:6144
    v_exp_f32 v70, v70
    v_exp_f32 v71, v71
    s_setprio 0
    v_mfma_f32_32x32x16_bf16 v[144:159], v[100:103], v[104:107], v[144:159]
    ds_read_b64_tr_b16 v[114:115], v198 offset:6656
    v_exp_f32 v72, v72
    v_exp_f32 v73, v73
    v_exp_f32 v74, v74
    v_mfma_f32_32x32x16_bf16 v[160:175], v[96:99], v[108:111], v[160:175]
    ds_read_b64_tr_b16 v[116:117], v199 offset:6144
    v_exp_f32 v75, v75
    v_exp_f32 v76, v76
    v_smfmac_f32_32x32x32_bf16 v[80:95], v[20:23], v[64:71], v207
    ds_read_b64_tr_b16 v[118:119], v199 offset:6656
    v_exp_f32 v77, v77
    v_exp_f32 v78, v78
    v_mfma_f32_32x32x16_bf16 v[176:191], v[100:103], v[108:111], v[176:191]
    v_exp_f32 v79, v79
    s_waitcnt vmcnt(0) lgkmcnt(0)
    s_barrier
    s_setprio 3
    v_exp_f32 v48, v48
    v_smfmac_f32_32x32x32_bf16 v[80:95], v[24:27], v[72:79], v207
    s_mov_b64 exec, s[52:53]
    ds_read_b128 v[20:23], v3 offset:18432
    ds_read_b128 v[24:27], v3 offset:18944
    s_mov_b64 exec, -1
    ds_read_b128 v[104:107], v236 offset:0
    s_lshl_b32 s59, s80, 1
    s_add_u32 m0, s59, 65536
    s_add_u32 s88, s86, 6
    s_and_b32 s88, s88, 7
    s_lshl_b32 s59, s88, 7
    s_add_u32 s59, s59, s82
    buffer_load_dwordx4 v196, s[36:39], s59 offen sc1 lds
    v_exp_f32 v49, v49
    v_exp_f32 v50, v50
    v_exp_f32 v51, v51
    v_mfma_f32_32x32x16_bf16 v[128:143], v[112:115], v[120:123], v[128:143]
    ds_read_b128 v[108:111], v236 offset:4096
    v_exp_f32 v52, v52
    v_exp_f32 v53, v53
    v_mfma_f32_32x32x16_bf16 v[64:79], v[8:11], v[4:7], v[32:47]
    ds_read_b128 v[8:11], v206 offset:20480
    ds_read_b64_tr_b16 v[96:97], v200 offset:0
    s_add_u32 m0, m0, 1024
    s_nop 0
    buffer_load_dwordx4 v197, s[36:39], s59 offen sc1 lds
    v_exp_f32 v54, v54
    v_exp_f32 v55, v55
    v_mfma_f32_32x32x16_bf16 v[144:159], v[116:119], v[120:123], v[144:159]
    ds_read_b64_tr_b16 v[98:99], v200 offset:512
    v_exp_f32 v56, v56
    v_exp_f32 v57, v57
    v_exp_f32 v58, v58
    v_mfma_f32_32x32x16_bf16 v[160:175], v[112:115], v[124:127], v[160:175]
    ds_read_b64_tr_b16 v[100:101], v201 offset:0
    s_add_u32 m0, s80, 81920
    s_add_u32 s88, s86, 6
    s_and_b32 s88, s88, 7
    s_mul_i32 s59, s88, 229376
    s_add_u32 s59, s59, s83
    buffer_load_dwordx4 v192, s[24:27], s59 offen lds
    v_exp_f32 v59, v59
    v_exp_f32 v60, v60
    v_smfmac_f32_32x32x32_bf16 v[80:95], v[12:15], v[48:55], v207
    ds_read_b64_tr_b16 v[102:103], v201 offset:512
    v_exp_f32 v61, v61
    v_exp_f32 v62, v62
    v_mfma_f32_32x32x16_bf16 v[176:191], v[116:119], v[124:127], v[176:191]
    v_exp_f32 v63, v63
    s_waitcnt lgkmcnt(0)
    v_exp_f32 v64, v64
    v_smfmac_f32_32x32x32_bf16 v[80:95], v[16:19], v[56:63], v207
    s_mov_b64 exec, s[52:53]
    ds_read_b128 v[12:15], v3 offset:20480
    ds_read_b128 v[16:19], v3 offset:20992
    s_mov_b64 exec, -1
    ds_read_b128 v[120:123], v237 offset:0
    s_add_u32 m0, s80, 90112
    s_nop 0
    buffer_load_dwordx4 v193, s[28:31], s59 offen lds
    v_exp_f32 v65, v65
    v_exp_f32 v66, v66
    v_exp_f32 v67, v67
    v_mfma_f32_32x32x16_bf16 v[128:143], v[96:99], v[104:107], v[128:143]
    ds_read_b128 v[124:127], v237 offset:4096
    v_exp_f32 v68, v68
    v_exp_f32 v69, v69
    v_mfma_f32_32x32x16_bf16 v[48:63], v[8:11], v[4:7], v[32:47]
    ds_read_b128 v[8:11], v206 offset:22528
    ds_read_b64_tr_b16 v[112:113], v200 offset:2048
    v_exp_f32 v70, v70
    v_exp_f32 v71, v71
    s_setprio 2
    v_mfma_f32_32x32x16_bf16 v[144:159], v[100:103], v[104:107], v[144:159]
    ds_read_b64_tr_b16 v[114:115], v200 offset:2560
    s_add_u32 m0, s80, 98304
    s_add_u32 s59, s59, 128
    buffer_load_dwordx4 v192, s[24:27], s59 offen lds
    v_exp_f32 v72, v72
    v_exp_f32 v73, v73
    v_exp_f32 v74, v74
    v_mfma_f32_32x32x16_bf16 v[160:175], v[96:99], v[108:111], v[160:175]
    ds_read_b64_tr_b16 v[116:117], v201 offset:2048
    v_exp_f32 v75, v75
    v_exp_f32 v76, v76
    v_smfmac_f32_32x32x32_bf16 v[80:95], v[20:23], v[64:71], v207
    ds_read_b64_tr_b16 v[118:119], v201 offset:2560
    v_exp_f32 v77, v77
    v_exp_f32 v78, v78
    v_mfma_f32_32x32x16_bf16 v[176:191], v[100:103], v[108:111], v[176:191]
    v_exp_f32 v79, v79
    s_waitcnt lgkmcnt(0)
    v_exp_f32 v48, v48
    v_smfmac_f32_32x32x32_bf16 v[80:95], v[24:27], v[72:79], v207
    s_mov_b64 exec, s[52:53]
    ds_read_b128 v[20:23], v3 offset:22528
    ds_read_b128 v[24:27], v3 offset:23040
    s_mov_b64 exec, -1
    ds_read_b128 v[104:107], v238 offset:0
    s_add_u32 m0, s80, 106496
    s_nop 0
    buffer_load_dwordx4 v193, s[28:31], s59 offen lds
    v_exp_f32 v49, v49
    v_exp_f32 v50, v50
    v_exp_f32 v51, v51
    v_mfma_f32_32x32x16_bf16 v[128:143], v[112:115], v[120:123], v[128:143]
    ds_read_b128 v[108:111], v238 offset:4096
    v_exp_f32 v52, v52
    v_exp_f32 v53, v53
    v_mfma_f32_32x32x16_bf16 v[64:79], v[8:11], v[4:7], v[32:47]
    ds_read_b128 v[8:11], v206 offset:0
    ds_read_b64_tr_b16 v[96:97], v200 offset:4096
    v_exp_f32 v54, v54
    v_exp_f32 v55, v55
    s_setprio 1
    v_mfma_f32_32x32x16_bf16 v[144:159], v[116:119], v[120:123], v[144:159]
    ds_read_b64_tr_b16 v[98:99], v200 offset:4608
    s_add_u32 m0, s80, 139264
    s_add_u32 s59, s81, 32768
    buffer_load_dwordx4 v2, s[32:35], s59 offen sc1 lds
    v_exp_f32 v56, v56
    v_exp_f32 v57, v57
    v_exp_f32 v58, v58
    v_mfma_f32_32x32x16_bf16 v[160:175], v[112:115], v[124:127], v[160:175]
    ds_read_b64_tr_b16 v[100:101], v201 offset:4096
    v_exp_f32 v59, v59
    v_exp_f32 v60, v60
    v_smfmac_f32_32x32x32_bf16 v[80:95], v[12:15], v[48:55], v207
    ds_read_b64_tr_b16 v[102:103], v201 offset:4608
    v_exp_f32 v61, v61
    v_exp_f32 v62, v62
    v_mfma_f32_32x32x16_bf16 v[176:191], v[116:119], v[124:127], v[176:191]
    v_exp_f32 v63, v63
    s_waitcnt lgkmcnt(0)
    v_exp_f32 v64, v64
    v_smfmac_f32_32x32x32_bf16 v[80:95], v[16:19], v[56:63], v207
    s_mov_b64 exec, s[52:53]
    ds_read_b128 v[12:15], v3 offset:0
    ds_read_b128 v[16:19], v3 offset:512
    s_mov_b64 exec, -1
    ds_read_b128 v[120:123], v239 offset:0
    v_exp_f32 v65, v65
    v_exp_f32 v66, v66
    v_exp_f32 v67, v67
    v_mfma_f32_32x32x16_bf16 v[128:143], v[96:99], v[104:107], v[128:143]
    ds_read_b128 v[124:127], v239 offset:4096
    v_exp_f32 v68, v68
    v_exp_f32 v69, v69
    v_mfma_f32_32x32x16_bf16 v[48:63], v[8:11], v[4:7], v[32:47]
    ds_read_b128 v[8:11], v206 offset:2048
    ds_read_b64_tr_b16 v[112:113], v200 offset:6144
    v_exp_f32 v70, v70
    v_exp_f32 v71, v71
    s_setprio 0
    v_mfma_f32_32x32x16_bf16 v[144:159], v[100:103], v[104:107], v[144:159]
    ds_read_b64_tr_b16 v[114:115], v200 offset:6656
    v_exp_f32 v72, v72
    v_exp_f32 v73, v73
    v_exp_f32 v74, v74
    v_mfma_f32_32x32x16_bf16 v[160:175], v[96:99], v[108:111], v[160:175]
    ds_read_b64_tr_b16 v[116:117], v201 offset:6144
    v_exp_f32 v75, v75
    v_exp_f32 v76, v76
    v_smfmac_f32_32x32x32_bf16 v[80:95], v[20:23], v[64:71], v207
    ds_read_b64_tr_b16 v[118:119], v201 offset:6656
    v_exp_f32 v77, v77
    v_exp_f32 v78, v78
    v_mfma_f32_32x32x16_bf16 v[176:191], v[100:103], v[108:111], v[176:191]
    v_exp_f32 v79, v79
    s_waitcnt vmcnt(0) lgkmcnt(0)
    s_barrier
    s_setprio 3
    v_exp_f32 v48, v48
    v_smfmac_f32_32x32x32_bf16 v[80:95], v[24:27], v[72:79], v207
    s_mov_b64 exec, s[52:53]
    ds_read_b128 v[20:23], v3 offset:2048
    ds_read_b128 v[24:27], v3 offset:2560
    s_mov_b64 exec, -1
    ds_read_b128 v[104:107], v232 offset:0
    s_lshl_b32 s59, s80, 1
    s_add_u32 m0, s59, 0
    s_add_u32 s88, s86, 7
    s_and_b32 s88, s88, 7
    s_lshl_b32 s59, s88, 7
    s_add_u32 s59, s59, s82
    buffer_load_dwordx4 v196, s[36:39], s59 offen sc1 lds
    v_exp_f32 v49, v49
    v_exp_f32 v50, v50
    v_exp_f32 v51, v51
    v_mfma_f32_32x32x16_bf16 v[128:143], v[112:115], v[120:123], v[128:143]
    ds_read_b128 v[108:111], v232 offset:4096
    v_exp_f32 v52, v52
    v_exp_f32 v53, v53
    v_mfma_f32_32x32x16_bf16 v[64:79], v[8:11], v[4:7], v[32:47]
    ds_read_b128 v[8:11], v206 offset:4096
    ds_read_b64_tr_b16 v[96:97], v198 offset:0
    s_add_u32 m0, m0, 1024
    s_nop 0
    buffer_load_dwordx4 v197, s[36:39], s59 offen sc1 lds
    v_exp_f32 v54, v54
    v_exp_f32 v55, v55
    v_mfma_f32_32x32x16_bf16 v[144:159], v[116:119], v[120:123], v[144:159]
    ds_read_b64_tr_b16 v[98:99], v198 offset:512
    v_exp_f32 v56, v56
    v_exp_f32 v57, v57
    v_exp_f32 v58, v58
    v_mfma_f32_32x32x16_bf16 v[160:175], v[112:115], v[124:127], v[160:175]
    ds_read_b64_tr_b16 v[100:101], v199 offset:0
    s_add_u32 m0, s80, 16384
    s_add_u32 s88, s86, 7
    s_and_b32 s88, s88, 7
    s_mul_i32 s59, s88, 229376
    s_add_u32 s59, s59, s83
    buffer_load_dwordx4 v192, s[24:27], s59 offen lds
    v_exp_f32 v59, v59
    v_exp_f32 v60, v60
    v_smfmac_f32_32x32x32_bf16 v[80:95], v[12:15], v[48:55], v207
    ds_read_b64_tr_b16 v[102:103], v199 offset:512
    v_exp_f32 v61, v61
    v_exp_f32 v62, v62
    v_mfma_f32_32x32x16_bf16 v[176:191], v[116:119], v[124:127], v[176:191]
    v_exp_f32 v63, v63
    s_waitcnt lgkmcnt(0)
    v_exp_f32 v64, v64
    v_smfmac_f32_32x32x32_bf16 v[80:95], v[16:19], v[56:63], v207
    s_mov_b64 exec, s[52:53]
    ds_read_b128 v[12:15], v3 offset:4096
    ds_read_b128 v[16:19], v3 offset:4608
    s_mov_b64 exec, -1
    ds_read_b128 v[120:123], v233 offset:0
    s_add_u32 m0, s80, 24576
    s_nop 0
    buffer_load_dwordx4 v193, s[28:31], s59 offen lds
    v_exp_f32 v65, v65
    v_exp_f32 v66, v66
    v_exp_f32 v67, v67
    v_mfma_f32_32x32x16_bf16 v[128:143], v[96:99], v[104:107], v[128:143]
    ds_read_b128 v[124:127], v233 offset:4096
    v_exp_f32 v68, v68
    v_exp_f32 v69, v69
    v_mfma_f32_32x32x16_bf16 v[48:63], v[8:11], v[4:7], v[32:47]
    ds_read_b128 v[8:11], v206 offset:6144
    ds_read_b64_tr_b16 v[112:113], v198 offset:2048
    v_exp_f32 v70, v70
    v_exp_f32 v71, v71
    s_setprio 2
    v_mfma_f32_32x32x16_bf16 v[144:159], v[100:103], v[104:107], v[144:159]
    ds_read_b64_tr_b16 v[114:115], v198 offset:2560
    s_add_u32 m0, s80, 32768
    s_add_u32 s59, s59, 128
    buffer_load_dwordx4 v192, s[24:27], s59 offen lds
    v_exp_f32 v72, v72
    v_exp_f32 v73, v73
    v_exp_f32 v74, v74
    v_mfma_f32_32x32x16_bf16 v[160:175], v[96:99], v[108:111], v[160:175]
    ds_read_b64_tr_b16 v[116:117], v199 offset:2048
    v_exp_f32 v75, v75
    v_exp_f32 v76, v76
    v_smfmac_f32_32x32x32_bf16 v[80:95], v[20:23], v[64:71], v207
    ds_read_b64_tr_b16 v[118:119], v199 offset:2560
    v_exp_f32 v77, v77
    v_exp_f32 v78, v78
    v_mfma_f32_32x32x16_bf16 v[176:191], v[100:103], v[108:111], v[176:191]
    v_exp_f32 v79, v79
    s_waitcnt lgkmcnt(0)
    v_exp_f32 v48, v48
    v_smfmac_f32_32x32x32_bf16 v[80:95], v[24:27], v[72:79], v207
    s_mov_b64 exec, s[52:53]
    ds_read_b128 v[20:23], v3 offset:6144
    ds_read_b128 v[24:27], v3 offset:6656
    s_mov_b64 exec, -1
    ds_read_b128 v[104:107], v234 offset:0
    s_add_u32 m0, s80, 40960
    s_nop 0
    buffer_load_dwordx4 v193, s[28:31], s59 offen lds
    v_exp_f32 v49, v49
    v_exp_f32 v50, v50
    v_exp_f32 v51, v51
    v_mfma_f32_32x32x16_bf16 v[128:143], v[112:115], v[120:123], v[128:143]
    ds_read_b128 v[108:111], v234 offset:4096
    v_exp_f32 v52, v52
    v_exp_f32 v53, v53
    v_mfma_f32_32x32x16_bf16 v[64:79], v[8:11], v[4:7], v[32:47]
    ds_read_b128 v[8:11], v206 offset:8192
    ds_read_b64_tr_b16 v[96:97], v198 offset:4096
    v_exp_f32 v54, v54
    v_exp_f32 v55, v55
    s_setprio 1
    v_mfma_f32_32x32x16_bf16 v[144:159], v[116:119], v[120:123], v[144:159]
    ds_read_b64_tr_b16 v[98:99], v198 offset:4608
    s_add_u32 m0, s80, 147456
    s_add_u32 s59, s81, 40960
    buffer_load_dwordx4 v2, s[32:35], s59 offen sc1 lds
    v_exp_f32 v56, v56
    v_exp_f32 v57, v57
    v_exp_f32 v58, v58
    v_mfma_f32_32x32x16_bf16 v[160:175], v[112:115], v[124:127], v[160:175]
    ds_read_b64_tr_b16 v[100:101], v199 offset:4096
    v_exp_f32 v59, v59
    v_exp_f32 v60, v60
    v_smfmac_f32_32x32x32_bf16 v[80:95], v[12:15], v[48:55], v207
    ds_read_b64_tr_b16 v[102:103], v199 offset:4608
    v_exp_f32 v61, v61
    v_exp_f32 v62, v62
    v_mfma_f32_32x32x16_bf16 v[176:191], v[116:119], v[124:127], v[176:191]
    v_exp_f32 v63, v63
    s_waitcnt lgkmcnt(0)
    v_exp_f32 v64, v64
    v_smfmac_f32_32x32x32_bf16 v[80:95], v[16:19], v[56:63], v207
    s_mov_b64 exec, s[52:53]
    ds_read_b128 v[12:15], v3 offset:8192
    ds_read_b128 v[16:19], v3 offset:8704
    s_mov_b64 exec, -1
    ds_read_b128 v[120:123], v235 offset:0
    v_exp_f32 v65, v65
    v_exp_f32 v66, v66
    v_exp_f32 v67, v67
    v_mfma_f32_32x32x16_bf16 v[128:143], v[96:99], v[104:107], v[128:143]
    ds_read_b128 v[124:127], v235 offset:4096
    v_exp_f32 v68, v68
    v_exp_f32 v69, v69
    v_mfma_f32_32x32x16_bf16 v[48:63], v[8:11], v[4:7], v[32:47]
    ds_read_b128 v[8:11], v206 offset:10240
    ds_read_b64_tr_b16 v[112:113], v198 offset:6144
    v_exp_f32 v70, v70
    v_exp_f32 v71, v71
    s_setprio 0
    v_mfma_f32_32x32x16_bf16 v[144:159], v[100:103], v[104:107], v[144:159]
    ds_read_b64_tr_b16 v[114:115], v198 offset:6656
    v_exp_f32 v72, v72
    v_exp_f32 v73, v73
    v_exp_f32 v74, v74
    v_mfma_f32_32x32x16_bf16 v[160:175], v[96:99], v[108:111], v[160:175]
    ds_read_b64_tr_b16 v[116:117], v199 offset:6144
    v_exp_f32 v75, v75
    v_exp_f32 v76, v76
    v_smfmac_f32_32x32x32_bf16 v[80:95], v[20:23], v[64:71], v207
    ds_read_b64_tr_b16 v[118:119], v199 offset:6656
    v_exp_f32 v77, v77
    v_exp_f32 v78, v78
    v_mfma_f32_32x32x16_bf16 v[176:191], v[100:103], v[108:111], v[176:191]
    v_exp_f32 v79, v79
    s_waitcnt vmcnt(0) lgkmcnt(0)
    s_barrier
    s_setprio 3
    v_exp_f32 v48, v48
    v_smfmac_f32_32x32x32_bf16 v[80:95], v[24:27], v[72:79], v207
    s_mov_b64 exec, s[52:53]
    ds_read_b128 v[20:23], v3 offset:10240
    ds_read_b128 v[24:27], v3 offset:10752
    s_mov_b64 exec, -1
    ds_read_b128 v[104:107], v236 offset:0
    s_add_u32 m0, s80, 131072
    s_add_u32 s59, s81, 49152
    buffer_load_dwordx4 v2, s[32:35], s59 offen sc1 lds
    v_exp_f32 v49, v49
    v_exp_f32 v50, v50
    v_exp_f32 v51, v51
    v_mfma_f32_32x32x16_bf16 v[128:143], v[112:115], v[120:123], v[128:143]
    ds_read_b128 v[108:111], v236 offset:4096
    v_exp_f32 v52, v52
    v_exp_f32 v53, v53
    v_mfma_f32_32x32x16_bf16 v[64:79], v[8:11], v[4:7], v[32:47]
    ds_read_b128 v[8:11], v206 offset:12288
    ds_read_b64_tr_b16 v[96:97], v200 offset:0
    v_exp_f32 v54, v54
    v_exp_f32 v55, v55
    v_mfma_f32_32x32x16_bf16 v[144:159], v[116:119], v[120:123], v[144:159]
    ds_read_b64_tr_b16 v[98:99], v200 offset:512
    s_lshl_b32 s90, s80, 2
    s_add_u32 m0, s90, 65536
    s_add_u32 s88, s87, 0
    s_sub_u32 s89, s88, 7
    s_cmp_ge_u32 s88, 7
    s_cselect_b32 s88, s89, s88
    s_lshl_b32 s59, s88, 18
    s_add_u32 s59, s59, s84
    buffer_load_dwordx4 v194, s[76:79], s59 offen lds
    v_exp_f32 v56, v56
    v_exp_f32 v57, v57
    v_exp_f32 v58, v58
    v_mfma_f32_32x32x16_bf16 v[160:175], v[112:115], v[124:127], v[160:175]
    ds_read_b64_tr_b16 v[100:101], v201 offset:0
    v_exp_f32 v59, v59
    v_exp_f32 v60, v60
    v_smfmac_f32_32x32x32_bf16 v[80:95], v[12:15], v[48:55], v207
    ds_read_b64_tr_b16 v[102:103], v201 offset:512
    v_exp_f32 v61, v61
    v_exp_f32 v62, v62
    v_mfma_f32_32x32x16_bf16 v[176:191], v[116:119], v[124:127], v[176:191]
    v_exp_f32 v63, v63
    s_waitcnt lgkmcnt(0)
    v_exp_f32 v64, v64
    v_smfmac_f32_32x32x32_bf16 v[80:95], v[16:19], v[56:63], v207
    s_mov_b64 exec, s[52:53]
    ds_read_b128 v[12:15], v3 offset:12288
    ds_read_b128 v[16:19], v3 offset:12800
    s_mov_b64 exec, -1
    ds_read_b128 v[120:123], v237 offset:0
    s_add_u32 m0, s90, 66560
    s_add_u32 s59, s59, 8192
    buffer_load_dwordx4 v194, s[76:79], s59 offen lds
    v_exp_f32 v65, v65
    v_exp_f32 v66, v66
    v_exp_f32 v67, v67
    v_mfma_f32_32x32x16_bf16 v[128:143], v[96:99], v[104:107], v[128:143]
    ds_read_b128 v[124:127], v237 offset:4096
    v_exp_f32 v68, v68
    v_exp_f32 v69, v69
    v_mfma_f32_32x32x16_bf16 v[48:63], v[8:11], v[4:7], v[32:47]
    ds_read_b128 v[8:11], v206 offset:14336
    ds_read_b64_tr_b16 v[112:113], v200 offset:2048
    v_exp_f32 v70, v70
    v_exp_f32 v71, v71
    s_setprio 2
    v_mfma_f32_32x32x16_bf16 v[144:159], v[100:103], v[104:107], v[144:159]
    ds_read_b64_tr_b16 v[114:115], v200 offset:2560
    s_add_u32 m0, s90, 67584
    s_add_u32 s59, s59, 8192
    buffer_load_dwordx4 v194, s[76:79], s59 offen lds
    v_exp_f32 v72, v72
    v_exp_f32 v73, v73
    v_exp_f32 v74, v74
    v_mfma_f32_32x32x16_bf16 v[160:175], v[96:99], v[108:111], v[160:175]
    ds_read_b64_tr_b16 v[116:117], v201 offset:2048
    v_exp_f32 v75, v75
    v_exp_f32 v76, v76
    v_smfmac_f32_32x32x32_bf16 v[80:95], v[20:23], v[64:71], v207
    ds_read_b64_tr_b16 v[118:119], v201 offset:2560
    v_exp_f32 v77, v77
    v_exp_f32 v78, v78
    v_mfma_f32_32x32x16_bf16 v[176:191], v[100:103], v[108:111], v[176:191]
    v_exp_f32 v79, v79
    s_waitcnt lgkmcnt(0)
    v_exp_f32 v48, v48
    v_smfmac_f32_32x32x32_bf16 v[80:95], v[24:27], v[72:79], v207
    s_mov_b64 exec, s[52:53]
    ds_read_b128 v[20:23], v3 offset:14336
    ds_read_b128 v[24:27], v3 offset:14848
    s_mov_b64 exec, -1
    ds_read_b128 v[104:107], v238 offset:0
    s_add_u32 m0, s90, 68608
    s_add_u32 s59, s59, 8192
    buffer_load_dwordx4 v194, s[76:79], s59 offen lds
    v_exp_f32 v49, v49
    v_exp_f32 v50, v50
    v_exp_f32 v51, v51
    v_mfma_f32_32x32x16_bf16 v[128:143], v[112:115], v[120:123], v[128:143]
    ds_read_b128 v[108:111], v238 offset:4096
    v_exp_f32 v52, v52
    v_exp_f32 v53, v53
    v_mfma_f32_32x32x16_bf16 v[64:79], v[8:11], v[4:7], v[32:47]
    ds_read_b128 v[8:11], v206 offset:16384
    ds_read_b64_tr_b16 v[96:97], v200 offset:4096
    v_exp_f32 v54, v54
    v_exp_f32 v55, v55
    s_setprio 1
    v_mfma_f32_32x32x16_bf16 v[144:159], v[116:119], v[120:123], v[144:159]
    ds_read_b64_tr_b16 v[98:99], v200 offset:4608
    s_lshl_b32 s59, s2, 3
    s_add_u32 s59, s59, s40
    s_lshl_b32 s59, s59, 8
    v_lshlrev_b32 v28, 7, v0
    s_mov_b64 exec, 3
    buffer_load_dword v195, v28, s[60:63], s59 offen
    s_mov_b64 exec, -1
    v_exp_f32 v56, v56
    v_exp_f32 v57, v57
    v_exp_f32 v58, v58
    v_mfma_f32_32x32x16_bf16 v[160:175], v[112:115], v[124:127], v[160:175]
    ds_read_b64_tr_b16 v[100:101], v201 offset:4096
    v_exp_f32 v59, v59
    v_exp_f32 v60, v60
    v_smfmac_f32_32x32x32_bf16 v[80:95], v[12:15], v[48:55], v207
    ds_read_b64_tr_b16 v[102:103], v201 offset:4608
    v_exp_f32 v61, v61
    v_exp_f32 v62, v62
    v_mfma_f32_32x32x16_bf16 v[176:191], v[116:119], v[124:127], v[176:191]
    v_exp_f32 v63, v63
    s_waitcnt lgkmcnt(0)
    v_exp_f32 v64, v64
    v_smfmac_f32_32x32x32_bf16 v[80:95], v[16:19], v[56:63], v207
    s_mov_b64 exec, s[52:53]
    ds_read_b128 v[12:15], v3 offset:16384
    ds_read_b128 v[16:19], v3 offset:16896
    s_mov_b64 exec, -1
    ds_read_b128 v[120:123], v239 offset:0
    v_exp_f32 v65, v65
    v_exp_f32 v66, v66
    v_exp_f32 v67, v67
    v_mfma_f32_32x32x16_bf16 v[128:143], v[96:99], v[104:107], v[128:143]
    ds_read_b128 v[124:127], v239 offset:4096
    v_exp_f32 v68, v68
    v_exp_f32 v69, v69
    v_mfma_f32_32x32x16_bf16 v[48:63], v[8:11], v[4:7], v[32:47]
    ds_read_b128 v[8:11], v206 offset:18432
    ds_read_b64_tr_b16 v[112:113], v200 offset:6144
    v_exp_f32 v70, v70
    v_exp_f32 v71, v71
    s_setprio 0
    v_mfma_f32_32x32x16_bf16 v[144:159], v[100:103], v[104:107], v[144:159]
    ds_read_b64_tr_b16 v[114:115], v200 offset:6656
    v_exp_f32 v72, v72
    v_exp_f32 v73, v73
    v_exp_f32 v74, v74
    v_mfma_f32_32x32x16_bf16 v[160:175], v[96:99], v[108:111], v[160:175]
    ds_read_b64_tr_b16 v[116:117], v201 offset:6144
    v_exp_f32 v75, v75
    v_exp_f32 v76, v76
    v_smfmac_f32_32x32x32_bf16 v[80:95], v[20:23], v[64:71], v207
    ds_read_b64_tr_b16 v[118:119], v201 offset:6656
    v_exp_f32 v77, v77
    v_exp_f32 v78, v78
    v_mfma_f32_32x32x16_bf16 v[176:191], v[100:103], v[108:111], v[176:191]
    v_exp_f32 v79, v79
    s_waitcnt vmcnt(5) lgkmcnt(0)
    s_barrier
    s_setprio 3
    v_exp_f32 v48, v48
    v_smfmac_f32_32x32x32_bf16 v[80:95], v[24:27], v[72:79], v207
    s_mov_b64 exec, s[52:53]
    ds_read_b128 v[20:23], v3 offset:18432
    ds_read_b128 v[24:27], v3 offset:18944
    s_mov_b64 exec, -1
    s_add_u32 m0, s80, 139264
    s_add_u32 s59, s81, 57344
    buffer_load_dwordx4 v2, s[32:35], s59 offen sc1 lds
    v_exp_f32 v49, v49
    v_exp_f32 v50, v50
    v_exp_f32 v51, v51
    v_mfma_f32_32x32x16_bf16 v[128:143], v[112:115], v[120:123], v[128:143]
    v_exp_f32 v52, v52
    v_exp_f32 v53, v53
    v_mfma_f32_32x32x16_bf16 v[64:79], v[8:11], v[4:7], v[32:47]
    ds_read_b128 v[8:11], v206 offset:20480
    v_exp_f32 v54, v54
    v_exp_f32 v55, v55
    v_mfma_f32_32x32x16_bf16 v[144:159], v[116:119], v[120:123], v[144:159]
    v_exp_f32 v56, v56
    v_exp_f32 v57, v57
    v_exp_f32 v58, v58
    v_mfma_f32_32x32x16_bf16 v[160:175], v[112:115], v[124:127], v[160:175]
    v_exp_f32 v59, v59
    v_exp_f32 v60, v60
    v_smfmac_f32_32x32x32_bf16 v[80:95], v[12:15], v[48:55], v207
    v_exp_f32 v61, v61
    v_exp_f32 v62, v62
    v_mfma_f32_32x32x16_bf16 v[176:191], v[116:119], v[124:127], v[176:191]
    v_exp_f32 v63, v63
    s_waitcnt lgkmcnt(0)
    v_exp_f32 v64, v64
    v_smfmac_f32_32x32x32_bf16 v[80:95], v[16:19], v[56:63], v207
    s_mov_b64 exec, s[52:53]
    ds_read_b128 v[12:15], v3 offset:20480
    ds_read_b128 v[16:19], v3 offset:20992
    s_mov_b64 exec, -1
    v_exp_f32 v65, v65
    v_exp_f32 v66, v66
    v_exp_f32 v67, v67
    v_exp_f32 v68, v68
    v_exp_f32 v69, v69
    v_mfma_f32_32x32x16_bf16 v[48:63], v[8:11], v[4:7], v[32:47]
    ds_read_b128 v[8:11], v206 offset:22528
    v_exp_f32 v70, v70
    v_exp_f32 v71, v71
    s_setprio 2
    v_exp_f32 v72, v72
    v_exp_f32 v73, v73
    v_exp_f32 v74, v74
    v_exp_f32 v75, v75
    v_exp_f32 v76, v76
    v_exp_f32 v77, v77
    v_exp_f32 v78, v78
    v_exp_f32 v79, v79
    v_max_f32 v128, 0, v128
    v_max_f32 v129, 0, v129
    v_max_f32 v130, 0, v130
    v_max_f32 v131, 0, v131
    v_max_f32 v132, 0, v132
    v_max_f32 v133, 0, v133
    v_max_f32 v134, 0, v134
    v_max_f32 v135, 0, v135
    v_mul_f32 v128, v128, v136
    v_mul_f32 v129, v129, v137
    v_mul_f32 v130, v130, v138
    v_mul_f32 v131, v131, v139
    v_mul_f32 v132, v132, v140
    v_mul_f32 v133, v133, v141
    v_mul_f32 v134, v134, v142
    v_mul_f32 v135, v135, v143
    v_cvt_pk_bf16_f32 v128, v128, v129
    v_cvt_pk_bf16_f32 v129, v130, v131
    v_cvt_pk_bf16_f32 v130, v132, v133
    v_cvt_pk_bf16_f32 v131, v134, v135
    v_smfmac_f32_32x32x32_bf16 v[80:95], v[20:23], v[64:71], v207
    buffer_store_dwordx4 v[128:131], v2, s[36:39], s54 offen offset:0 sc1
    v_max_f32 v144, 0, v144
    v_max_f32 v145, 0, v145
    v_max_f32 v146, 0, v146
    v_max_f32 v147, 0, v147
    v_max_f32 v148, 0, v148
    v_max_f32 v149, 0, v149
    v_max_f32 v150, 0, v150
    v_max_f32 v151, 0, v151
    v_mul_f32 v144, v144, v152
    v_mul_f32 v145, v145, v153
    v_mul_f32 v146, v146, v154
    v_mul_f32 v147, v147, v155
    v_mul_f32 v148, v148, v156
    v_mul_f32 v149, v149, v157
    v_mul_f32 v150, v150, v158
    v_mul_f32 v151, v151, v159
    v_cvt_pk_bf16_f32 v144, v144, v145
    v_cvt_pk_bf16_f32 v145, v146, v147
    v_cvt_pk_bf16_f32 v146, v148, v149
    v_cvt_pk_bf16_f32 v147, v150, v151
    buffer_store_dwordx4 v[144:147], v2, s[36:39], s54 offen offset:1024 sc1
    s_waitcnt lgkmcnt(0)
    v_exp_f32 v48, v48
    v_smfmac_f32_32x32x32_bf16 v[80:95], v[24:27], v[72:79], v207
    s_mov_b64 exec, s[52:53]
    ds_read_b128 v[20:23], v3 offset:22528
    ds_read_b128 v[24:27], v3 offset:23040
    s_mov_b64 exec, -1
    v_exp_f32 v49, v49
    v_exp_f32 v50, v50
    v_exp_f32 v51, v51
    v_exp_f32 v52, v52
    v_exp_f32 v53, v53
    v_mfma_f32_32x32x16_bf16 v[64:79], v[8:11], v[4:7], v[32:47]
    ds_read_b128 v[8:11], v206 offset:0
    v_exp_f32 v54, v54
    v_exp_f32 v55, v55
    s_setprio 1
    v_exp_f32 v56, v56
    v_exp_f32 v57, v57
    v_exp_f32 v58, v58
    v_exp_f32 v59, v59
    v_exp_f32 v60, v60
    v_exp_f32 v61, v61
    v_exp_f32 v62, v62
    v_exp_f32 v63, v63
    v_max_f32 v160, 0, v160
    v_max_f32 v161, 0, v161
    v_max_f32 v162, 0, v162
    v_max_f32 v163, 0, v163
    v_max_f32 v164, 0, v164
    v_max_f32 v165, 0, v165
    v_max_f32 v166, 0, v166
    v_max_f32 v167, 0, v167
    v_mul_f32 v160, v160, v168
    v_mul_f32 v161, v161, v169
    v_mul_f32 v162, v162, v170
    v_mul_f32 v163, v163, v171
    v_mul_f32 v164, v164, v172
    v_mul_f32 v165, v165, v173
    v_mul_f32 v166, v166, v174
    v_mul_f32 v167, v167, v175
    v_cvt_pk_bf16_f32 v160, v160, v161
    v_cvt_pk_bf16_f32 v161, v162, v163
    v_cvt_pk_bf16_f32 v162, v164, v165
    v_cvt_pk_bf16_f32 v163, v166, v167
    v_smfmac_f32_32x32x32_bf16 v[80:95], v[12:15], v[48:55], v207
    buffer_store_dwordx4 v[160:163], v2, s[36:39], s55 offen offset:0 sc1
    v_max_f32 v176, 0, v176
    v_max_f32 v177, 0, v177
    v_max_f32 v178, 0, v178
    v_max_f32 v179, 0, v179
    v_max_f32 v180, 0, v180
    v_max_f32 v181, 0, v181
    v_max_f32 v182, 0, v182
    v_max_f32 v183, 0, v183
    v_mul_f32 v176, v176, v184
    v_mul_f32 v177, v177, v185
    v_mul_f32 v178, v178, v186
    v_mul_f32 v179, v179, v187
    v_mul_f32 v180, v180, v188
    v_mul_f32 v181, v181, v189
    v_mul_f32 v182, v182, v190
    v_mul_f32 v183, v183, v191
    v_cvt_pk_bf16_f32 v176, v176, v177
    v_cvt_pk_bf16_f32 v177, v178, v179
    v_cvt_pk_bf16_f32 v178, v180, v181
    v_cvt_pk_bf16_f32 v179, v182, v183
    buffer_store_dwordx4 v[176:179], v2, s[36:39], s55 offen offset:1024 sc1
    s_waitcnt lgkmcnt(0)
    v_exp_f32 v64, v64
    v_smfmac_f32_32x32x32_bf16 v[80:95], v[16:19], v[56:63], v207
    s_mov_b64 exec, s[52:53]
    ds_read_b128 v[12:15], v3 offset:0
    ds_read_b128 v[16:19], v3 offset:512
    s_mov_b64 exec, -1
    v_exp_f32 v65, v65
    v_exp_f32 v66, v66
    v_exp_f32 v67, v67
    v_exp_f32 v68, v68
    v_exp_f32 v69, v69
    v_mfma_f32_32x32x16_bf16 v[48:63], v[8:11], v[4:7], v[32:47]
    ds_read_b128 v[8:11], v206 offset:2048
    v_exp_f32 v70, v70
    v_exp_f32 v71, v71
    s_setprio 0
    v_exp_f32 v72, v72
    v_exp_f32 v73, v73
    v_exp_f32 v74, v74
    v_exp_f32 v75, v75
    v_smfmac_f32_32x32x32_bf16 v[80:95], v[20:23], v[64:71], v207
    v_exp_f32 v76, v76
    v_exp_f32 v77, v77
    v_exp_f32 v78, v78
    v_exp_f32 v79, v79
idle_merge:
    s_waitcnt vmcnt(4) lgkmcnt(0)
    s_barrier
    s_lshl_b32 s56, s43, 4
    s_add_u32 s56, s56, 4096
    v_lshrrev_b32 v30, 2, v0
    v_add_u32 v30, s56, v30
    v_lshlrev_b32 v30, 7, v30
    v_and_b32 v31, 3, v0
    v_lshl_add_u32 v30, v31, 2, v30
    v_and_b32 v31, 7, v0
    s_lshl_b32 s56, s43, 3
    v_add_u32 v31, s56, v31
    v_lshlrev_b32 v31, 7, v31
    v_cmp_lt_u32 vcc, 55, v0
    s_mov_b32 s56, 22020096
    s_cmp_eq_u32 s40, 7
    s_cselect_b32 s56, s56, 0x7ff00000
    v_cndmask_b32 v30, v30, v31, vcc
    s_setprio 3
    v_exp_f32 v48, v48
    v_smfmac_f32_32x32x32_bf16 v[80:95], v[24:27], v[72:79], v207
    s_mov_b64 exec, s[52:53]
    ds_read_b128 v[20:23], v3 offset:2048
    ds_read_b128 v[24:27], v3 offset:2560
    s_mov_b64 exec, -1
    s_add_u32 m0, s80, 147456
    s_add_u32 s59, s81, 65536
    buffer_load_dwordx4 v2, s[32:35], s59 offen sc1 lds
    v_exp_f32 v49, v49
    v_exp_f32 v50, v50
    v_exp_f32 v51, v51
    v_exp_f32 v52, v52
    v_exp_f32 v53, v53
    v_mfma_f32_32x32x16_bf16 v[64:79], v[8:11], v[4:7], v[32:47]
    ds_read_b128 v[8:11], v206 offset:4096
    v_exp_f32 v54, v54
    v_exp_f32 v55, v55
    v_exp_f32 v56, v56
    v_exp_f32 v57, v57
    v_exp_f32 v58, v58
    v_exp_f32 v59, v59
    v_smfmac_f32_32x32x32_bf16 v[80:95], v[12:15], v[48:55], v207
    v_exp_f32 v60, v60
    v_exp_f32 v61, v61
    v_exp_f32 v62, v62
    v_exp_f32 v63, v63
    s_waitcnt vmcnt(1)
    s_lshl_b32 s59, s46, 1
    s_add_u32 s59, s59, s41
    s_lshl_b32 s59, s59, 4
    s_add_u32 s59, s59, s47
    s_lshl_b32 s59, s59, 5
    s_lshr_b32 s68, s40, 1
    s_add_u32 s59, s59, s68
    s_lshl_b32 s59, s59, 2
    s_add_u32 s59, s59, 22544384
    s_cmp_lg_u32 s44, 7
    s_cselect_b32 s59, s59, 0x7ffffff0
    v_mov_b32 v28, s58
    v_mov_b32 v29, 0
    s_mov_b64 exec, 1
    buffer_store_dword v28, v29, s[32:35], s59 offen sc1
    s_mov_b64 exec, -1
    s_waitcnt lgkmcnt(0)
    v_exp_f32 v64, v64
    v_smfmac_f32_32x32x32_bf16 v[80:95], v[16:19], v[56:63], v207
    s_mov_b64 exec, s[52:53]
    ds_read_b128 v[12:15], v3 offset:4096
    ds_read_b128 v[16:19], v3 offset:4608
    s_mov_b64 exec, -1
    v_exp_f32 v65, v65
    v_exp_f32 v66, v66
    v_exp_f32 v67, v67
    v_exp_f32 v68, v68
    v_exp_f32 v69, v69
    v_mfma_f32_32x32x16_bf16 v[48:63], v[8:11], v[4:7], v[32:47]
    ds_read_b128 v[8:11], v206 offset:6144
    v_exp_f32 v70, v70
    v_exp_f32 v71, v71
    s_setprio 2
    v_exp_f32 v72, v72
    v_exp_f32 v73, v73
    v_exp_f32 v74, v74
    v_exp_f32 v75, v75
    v_smfmac_f32_32x32x32_bf16 v[80:95], v[20:23], v[64:71], v207
    v_exp_f32 v76, v76
    v_exp_f32 v77, v77
    v_exp_f32 v78, v78
    v_exp_f32 v79, v79
    s_waitcnt lgkmcnt(0)
    v_exp_f32 v48, v48
    v_smfmac_f32_32x32x32_bf16 v[80:95], v[24:27], v[72:79], v207
    s_mov_b64 exec, s[52:53]
    ds_read_b128 v[20:23], v3 offset:6144
    ds_read_b128 v[24:27], v3 offset:6656
    s_mov_b64 exec, -1
    v_exp_f32 v49, v49
    v_exp_f32 v50, v50
    v_exp_f32 v51, v51
    v_exp_f32 v52, v52
    v_exp_f32 v53, v53
    v_mfma_f32_32x32x16_bf16 v[64:79], v[8:11], v[4:7], v[32:47]
    ds_read_b128 v[8:11], v206 offset:8192
    v_exp_f32 v54, v54
    v_exp_f32 v55, v55
    s_setprio 1
    v_exp_f32 v56, v56
    v_exp_f32 v57, v57
    v_exp_f32 v58, v58
    v_exp_f32 v59, v59
    v_smfmac_f32_32x32x32_bf16 v[80:95], v[12:15], v[48:55], v207
    v_exp_f32 v60, v60
    v_exp_f32 v61, v61
    v_exp_f32 v62, v62
    v_exp_f32 v63, v63
    s_waitcnt lgkmcnt(0)
    v_exp_f32 v64, v64
    v_smfmac_f32_32x32x32_bf16 v[80:95], v[16:19], v[56:63], v207
    s_mov_b64 exec, s[52:53]
    ds_read_b128 v[12:15], v3 offset:8192
    ds_read_b128 v[16:19], v3 offset:8704
    s_mov_b64 exec, -1
    v_exp_f32 v65, v65
    v_exp_f32 v66, v66
    v_exp_f32 v67, v67
    v_exp_f32 v68, v68
    v_exp_f32 v69, v69
    v_mfma_f32_32x32x16_bf16 v[48:63], v[8:11], v[4:7], v[32:47]
    ds_read_b128 v[8:11], v206 offset:10240
    v_exp_f32 v70, v70
    v_exp_f32 v71, v71
    s_setprio 0
    v_exp_f32 v72, v72
    v_exp_f32 v73, v73
    v_exp_f32 v74, v74
    v_exp_f32 v75, v75
    v_smfmac_f32_32x32x32_bf16 v[80:95], v[20:23], v[64:71], v207
    v_exp_f32 v76, v76
    v_exp_f32 v77, v77
    v_exp_f32 v78, v78
    v_exp_f32 v79, v79
    s_waitcnt vmcnt(1) lgkmcnt(0)
    s_barrier
    s_setprio 3
    v_exp_f32 v48, v48
    v_smfmac_f32_32x32x32_bf16 v[80:95], v[24:27], v[72:79], v207
    s_mov_b64 exec, s[52:53]
    ds_read_b128 v[20:23], v3 offset:10240
    ds_read_b128 v[24:27], v3 offset:10752
    s_mov_b64 exec, -1
    s_add_u32 m0, s80, 131072
    s_add_u32 s59, s81, 73728
    buffer_load_dwordx4 v2, s[32:35], s59 offen sc1 lds
    v_exp_f32 v49, v49
    v_exp_f32 v50, v50
    v_exp_f32 v51, v51
    v_exp_f32 v52, v52
    v_exp_f32 v53, v53
    v_mfma_f32_32x32x16_bf16 v[64:79], v[8:11], v[4:7], v[32:47]
    ds_read_b128 v[8:11], v206 offset:12288
    s_lshl_b32 s90, s80, 2
    s_add_u32 m0, s90, 0
    s_mov_b32 s59, s84
    buffer_load_dwordx4 v194, s[60:63], s59 offen lds
    v_exp_f32 v54, v54
    v_exp_f32 v55, v55
    v_exp_f32 v56, v56
    v_exp_f32 v57, v57
    v_exp_f32 v58, v58
    v_exp_f32 v59, v59
    v_smfmac_f32_32x32x32_bf16 v[80:95], v[12:15], v[48:55], v207
    s_add_u32 m0, s90, 1024
    s_add_u32 s59, s59, 8192
    buffer_load_dwordx4 v194, s[60:63], s59 offen lds
    v_exp_f32 v60, v60
    v_exp_f32 v61, v61
    v_exp_f32 v62, v62
    v_exp_f32 v63, v63
    s_waitcnt lgkmcnt(0)
    v_exp_f32 v64, v64
    v_smfmac_f32_32x32x32_bf16 v[80:95], v[16:19], v[56:63], v207
    s_mov_b64 exec, s[52:53]
    ds_read_b128 v[12:15], v3 offset:12288
    ds_read_b128 v[16:19], v3 offset:12800
    s_mov_b64 exec, -1
    s_add_u32 m0, s90, 2048
    s_add_u32 s59, s59, 8192
    buffer_load_dwordx4 v194, s[60:63], s59 offen lds
    v_exp_f32 v65, v65
    v_exp_f32 v66, v66
    v_exp_f32 v67, v67
    v_exp_f32 v68, v68
    v_exp_f32 v69, v69
    v_mfma_f32_32x32x16_bf16 v[48:63], v[8:11], v[4:7], v[32:47]
    ds_read_b128 v[8:11], v206 offset:14336
    s_add_u32 m0, s90, 3072
    s_add_u32 s59, s59, 8192
    buffer_load_dwordx4 v194, s[60:63], s59 offen lds
    v_exp_f32 v70, v70
    v_exp_f32 v71, v71
    s_setprio 2
    v_exp_f32 v72, v72
    v_exp_f32 v73, v73
    v_exp_f32 v74, v74
    v_exp_f32 v75, v75
    v_smfmac_f32_32x32x32_bf16 v[80:95], v[20:23], v[64:71], v207
    s_lshl_b32 s90, s80, 2
    s_add_u32 m0, s90, 32768
    s_add_u32 s59, s84, 262144
    buffer_load_dwordx4 v194, s[60:63], s59 offen lds
    v_exp_f32 v76, v76
    v_exp_f32 v77, v77
    v_exp_f32 v78, v78
    v_exp_f32 v79, v79
    s_waitcnt lgkmcnt(0)
    v_exp_f32 v48, v48
    v_smfmac_f32_32x32x32_bf16 v[80:95], v[24:27], v[72:79], v207
    s_mov_b64 exec, s[52:53]
    ds_read_b128 v[20:23], v3 offset:14336
    ds_read_b128 v[24:27], v3 offset:14848
    s_mov_b64 exec, -1
    s_add_u32 m0, s90, 33792
    s_add_u32 s59, s59, 8192
    buffer_load_dwordx4 v194, s[60:63], s59 offen lds
    v_exp_f32 v49, v49
    v_exp_f32 v50, v50
    v_exp_f32 v51, v51
    v_exp_f32 v52, v52
    v_exp_f32 v53, v53
    v_mfma_f32_32x32x16_bf16 v[64:79], v[8:11], v[4:7], v[32:47]
    ds_read_b128 v[8:11], v206 offset:16384
    s_add_u32 m0, s90, 34816
    s_add_u32 s59, s59, 8192
    buffer_load_dwordx4 v194, s[60:63], s59 offen lds
    v_exp_f32 v54, v54
    v_exp_f32 v55, v55
    s_setprio 1
    v_exp_f32 v56, v56
    v_exp_f32 v57, v57
    v_exp_f32 v58, v58
    v_exp_f32 v59, v59
    v_smfmac_f32_32x32x32_bf16 v[80:95], v[12:15], v[48:55], v207
    s_add_u32 m0, s90, 35840
    s_add_u32 s59, s59, 8192
    buffer_load_dwordx4 v194, s[60:63], s59 offen lds
    v_exp_f32 v60, v60
    v_exp_f32 v61, v61
    v_exp_f32 v62, v62
    v_exp_f32 v63, v63
    s_waitcnt lgkmcnt(0)
    v_exp_f32 v64, v64
    v_smfmac_f32_32x32x32_bf16 v[80:95], v[16:19], v[56:63], v207
    s_mov_b64 exec, s[52:53]
    ds_read_b128 v[12:15], v3 offset:16384
    ds_read_b128 v[16:19], v3 offset:16896
    s_mov_b64 exec, -1
    v_exp_f32 v65, v65
    v_exp_f32 v66, v66
    v_exp_f32 v67, v67
    v_exp_f32 v68, v68
    v_exp_f32 v69, v69
    v_mfma_f32_32x32x16_bf16 v[48:63], v[8:11], v[4:7], v[32:47]
    ds_read_b128 v[8:11], v206 offset:18432
    v_exp_f32 v70, v70
    v_exp_f32 v71, v71
    s_setprio 0
    v_exp_f32 v72, v72
    v_exp_f32 v73, v73
    v_exp_f32 v74, v74
    v_exp_f32 v75, v75
    v_smfmac_f32_32x32x32_bf16 v[80:95], v[20:23], v[64:71], v207
    v_exp_f32 v76, v76
    v_exp_f32 v77, v77
    v_exp_f32 v78, v78
    v_exp_f32 v79, v79
    s_lshl_b32 s68, s101, 3
    v_add_u32 v230, s68, v204
    v_add_u32 v231, s68, v205
    s_waitcnt vmcnt(0) lgkmcnt(0)
    s_barrier
    s_setprio 3
    v_exp_f32 v48, v48
    v_smfmac_f32_32x32x32_bf16 v[80:95], v[24:27], v[72:79], v207
    s_mov_b64 exec, s[52:53]
    ds_read_b128 v[20:23], v3 offset:18432
    ds_read_b128 v[24:27], v3 offset:18944
    s_mov_b64 exec, -1
    ds_read_b64_tr_b16 v[160:161], v230 offset:0
    ds_read_b64_tr_b16 v[162:163], v230 offset:1024
    ds_read_b64_tr_b16 v[164:165], v231 offset:0
    ds_read_b64_tr_b16 v[166:167], v231 offset:1024
    s_add_u32 m0, s80, 139264
    s_add_u32 s59, s81, 81920
    buffer_load_dwordx4 v2, s[32:35], s59 offen sc1 lds
    v_exp_f32 v49, v49
    v_exp_f32 v50, v50
    v_exp_f32 v51, v51
    v_exp_f32 v52, v52
    v_exp_f32 v53, v53
    v_mfma_f32_32x32x16_bf16 v[64:79], v[8:11], v[4:7], v[32:47]
    ds_read_b128 v[8:11], v206 offset:20480
    ds_read_b64_tr_b16 v[168:169], v230 offset:2048
    ds_read_b64_tr_b16 v[170:171], v230 offset:3072
    ds_read_b64_tr_b16 v[172:173], v231 offset:2048
    ds_read_b64_tr_b16 v[174:175], v231 offset:3072
    s_lshl_b32 s90, s80, 2
    s_add_u32 m0, s90, 98304
    s_add_u32 s88, s87, 1
    s_sub_u32 s89, s88, 7
    s_cmp_ge_u32 s88, 7
    s_cselect_b32 s88, s89, s88
    s_lshl_b32 s59, s88, 18
    s_add_u32 s59, s59, s84
    buffer_load_dwordx4 v194, s[76:79], s59 offen lds
    v_exp_f32 v54, v54
    v_exp_f32 v55, v55
    v_exp_f32 v56, v56
    v_exp_f32 v57, v57
    v_exp_f32 v58, v58
    v_exp_f32 v59, v59
    v_smfmac_f32_32x32x32_bf16 v[80:95], v[12:15], v[48:55], v207
    v_exp_f32 v60, v60
    v_exp_f32 v61, v61
    v_exp_f32 v62, v62
    v_exp_f32 v63, v63
    s_waitcnt lgkmcnt(0)
    v_exp_f32 v64, v64
    v_smfmac_f32_32x32x32_bf16 v[80:95], v[16:19], v[56:63], v207
    s_mov_b64 exec, s[52:53]
    ds_read_b128 v[12:15], v3 offset:20480
    ds_read_b128 v[16:19], v3 offset:20992
    s_mov_b64 exec, -1
    ds_read_b64_tr_b16 v[176:177], v230 offset:4096
    ds_read_b64_tr_b16 v[178:179], v230 offset:5120
    ds_read_b64_tr_b16 v[180:181], v231 offset:4096
    ds_read_b64_tr_b16 v[182:183], v231 offset:5120
    s_add_u32 m0, s90, 99328
    s_add_u32 s59, s59, 8192
    buffer_load_dwordx4 v194, s[76:79], s59 offen lds
    v_exp_f32 v65, v65
    v_exp_f32 v66, v66
    v_exp_f32 v67, v67
    v_exp_f32 v68, v68
    v_exp_f32 v69, v69
    v_mfma_f32_32x32x16_bf16 v[48:63], v[8:11], v[4:7], v[32:47]
    ds_read_b128 v[8:11], v206 offset:22528
    ds_read_b64_tr_b16 v[184:185], v230 offset:6144
    ds_read_b64_tr_b16 v[186:187], v230 offset:7168
    ds_read_b64_tr_b16 v[188:189], v231 offset:6144
    ds_read_b64_tr_b16 v[190:191], v231 offset:7168
    v_exp_f32 v70, v70
    v_exp_f32 v71, v71
    s_setprio 2
    v_exp_f32 v72, v72
    v_exp_f32 v73, v73
    v_exp_f32 v74, v74
    v_exp_f32 v75, v75
    v_smfmac_f32_32x32x32_bf16 v[80:95], v[20:23], v[64:71], v207
    v_exp_f32 v76, v76
    v_exp_f32 v77, v77
    v_exp_f32 v78, v78
    v_exp_f32 v79, v79
    buffer_load_dword v31, v30, s[32:35], s56 offen sc1
    s_waitcnt lgkmcnt(0)
    v_exp_f32 v48, v48
    v_smfmac_f32_32x32x32_bf16 v[80:95], v[24:27], v[72:79], v207
    s_mov_b64 exec, s[52:53]
    ds_read_b128 v[20:23], v3 offset:22528
    ds_read_b128 v[24:27], v3 offset:23040
    s_mov_b64 exec, -1
    ds_read_b64_tr_b16 v[208:209], v230 offset:8192
    ds_read_b64_tr_b16 v[210:211], v230 offset:9216
    ds_read_b64_tr_b16 v[212:213], v231 offset:8192
    ds_read_b64_tr_b16 v[214:215], v231 offset:9216
    s_add_u32 m0, s90, 100352
    s_add_u32 s59, s59, 8192
    buffer_load_dwordx4 v194, s[76:79], s59 offen lds
    v_exp_f32 v49, v49
    v_exp_f32 v50, v50
    v_exp_f32 v51, v51
    v_exp_f32 v52, v52
    v_exp_f32 v53, v53
    v_mfma_f32_32x32x16_bf16 v[64:79], v[8:11], v[4:7], v[32:47]
    ds_read_b128 v[8:11], v206 offset:0
    ds_read_b64_tr_b16 v[216:217], v230 offset:10240
    ds_read_b64_tr_b16 v[218:219], v230 offset:11264
    ds_read_b64_tr_b16 v[220:221], v231 offset:10240
    ds_read_b64_tr_b16 v[222:223], v231 offset:11264
    v_exp_f32 v54, v54
    v_exp_f32 v55, v55
    s_setprio 1
    v_exp_f32 v56, v56
    v_exp_f32 v57, v57
    v_exp_f32 v58, v58
    v_exp_f32 v59, v59
    v_smfmac_f32_32x32x32_bf16 v[80:95], v[12:15], v[48:55], v207
    v_exp_f32 v60, v60
    v_exp_f32 v61, v61
    v_exp_f32 v62, v62
    v_exp_f32 v63, v63
    s_waitcnt lgkmcnt(0)
    v_exp_f32 v64, v64
    v_smfmac_f32_32x32x32_bf16 v[80:95], v[16:19], v[56:63], v207
    s_mov_b64 exec, s[52:53]
    ds_read_b128 v[12:15], v3 offset:0
    ds_read_b128 v[16:19], v3 offset:512
    s_mov_b64 exec, -1
    ds_read_b64_tr_b16 v[232:233], v230 offset:12288
    ds_read_b64_tr_b16 v[234:235], v230 offset:13312
    ds_read_b64_tr_b16 v[236:237], v231 offset:12288
    ds_read_b64_tr_b16 v[238:239], v231 offset:13312
    s_add_u32 m0, s90, 101376
    s_add_u32 s59, s59, 8192
    buffer_load_dwordx4 v194, s[76:79], s59 offen lds
    v_exp_f32 v65, v65
    v_exp_f32 v66, v66
    v_exp_f32 v67, v67
    v_exp_f32 v68, v68
    v_exp_f32 v69, v69
    v_mfma_f32_32x32x16_bf16 v[48:63], v[8:11], v[4:7], v[32:47]
    ds_read_b128 v[8:11], v206 offset:2048
    ds_read_b64_tr_b16 v[240:241], v230 offset:14336
    ds_read_b64_tr_b16 v[242:243], v230 offset:15360
    ds_read_b64_tr_b16 v[244:245], v231 offset:14336
    ds_read_b64_tr_b16 v[246:247], v231 offset:15360
    v_exp_f32 v70, v70
    v_exp_f32 v71, v71
    s_setprio 0
    v_exp_f32 v72, v72
    v_exp_f32 v73, v73
    v_exp_f32 v74, v74
    v_exp_f32 v75, v75
    v_smfmac_f32_32x32x32_bf16 v[80:95], v[20:23], v[64:71], v207
    v_exp_f32 v76, v76
    v_exp_f32 v77, v77
    v_exp_f32 v78, v78
    v_exp_f32 v79, v79
    s_cmp_eq_u32 s40, 7
    s_cbranch_scc0 m_c3_ret
    s_waitcnt vmcnt(2)
    v_cmp_ne_u32 vcc, s58, v31
    s_nop 4
    s_cbranch_vccnz m_c3_spin
    m_c3_ret:
    s_waitcnt vmcnt(5) lgkmcnt(0)
    s_barrier
    s_setprio 3
    v_exp_f32 v48, v48
    v_smfmac_f32_32x32x32_bf16 v[80:95], v[24:27], v[72:79], v207
    s_mov_b64 exec, s[52:53]
    ds_read_b128 v[20:23], v3 offset:2048
    ds_read_b128 v[24:27], v3 offset:2560
    s_mov_b64 exec, -1
    s_add_u32 m0, s80, 147456
    s_add_u32 s59, s81, 90112
    buffer_load_dwordx4 v2, s[32:35], s59 offen sc1 lds
    v_exp_f32 v49, v49
    v_exp_f32 v50, v50
    v_exp_f32 v51, v51
    v_exp_f32 v52, v52
    v_exp_f32 v53, v53
    v_mfma_f32_32x32x16_bf16 v[64:79], v[8:11], v[4:7], v[32:47]
    ds_read_b128 v[8:11], v206 offset:4096
    s_lshl_b32 s90, s80, 2
    s_add_u32 m0, s90, 0
    s_add_u32 s88, s87, 2
    s_sub_u32 s89, s88, 7
    s_cmp_ge_u32 s88, 7
    s_cselect_b32 s88, s89, s88
    s_lshl_b32 s59, s88, 18
    s_add_u32 s59, s59, s84
    buffer_load_dwordx4 v194, s[76:79], s59 offen lds
    v_exp_f32 v54, v54
    v_exp_f32 v55, v55
    v_exp_f32 v56, v56
    v_exp_f32 v57, v57
    v_exp_f32 v58, v58
    v_exp_f32 v59, v59
    v_smfmac_f32_32x32x32_bf16 v[80:95], v[12:15], v[48:55], v207
    v_exp_f32 v60, v60
    v_exp_f32 v61, v61
    v_exp_f32 v62, v62
    v_exp_f32 v63, v63
    s_waitcnt lgkmcnt(0)
    v_exp_f32 v64, v64
    v_smfmac_f32_32x32x32_bf16 v[80:95], v[16:19], v[56:63], v207
    s_mov_b64 exec, s[52:53]
    ds_read_b128 v[12:15], v3 offset:4096
    ds_read_b128 v[16:19], v3 offset:4608
    s_mov_b64 exec, -1
    s_add_u32 m0, s90, 1024
    s_add_u32 s59, s59, 8192
    buffer_load_dwordx4 v194, s[76:79], s59 offen lds
    v_exp_f32 v65, v65
    v_exp_f32 v66, v66
    v_exp_f32 v67, v67
    v_exp_f32 v68, v68
    v_exp_f32 v69, v69
    v_mfma_f32_32x32x16_bf16 v[48:63], v[8:11], v[4:7], v[32:47]
    ds_read_b128 v[8:11], v206 offset:6144
    v_exp_f32 v70, v70
    v_exp_f32 v71, v71
    s_setprio 2
    v_exp_f32 v72, v72
    v_exp_f32 v73, v73
    v_exp_f32 v74, v74
    v_exp_f32 v75, v75
    v_smfmac_f32_32x32x32_bf16 v[80:95], v[20:23], v[64:71], v207
    v_exp_f32 v76, v76
    v_exp_f32 v77, v77
    v_exp_f32 v78, v78
    v_exp_f32 v79, v79
    s_add_u32 s88, s87, 0
    s_sub_u32 s89, s88, 7
    s_cmp_ge_u32 s88, 7
    s_cselect_b32 s88, s89, s88
    s_lshl_b32 s75, s88, 14
    s_add_u32 s75, s75, s85
    buffer_load_dwordx4 v[104:107], v2, s[32:35], s75 offen offset:0 sc1
    s_waitcnt lgkmcnt(0)
    v_exp_f32 v48, v48
    v_smfmac_f32_32x32x32_bf16 v[80:95], v[24:27], v[72:79], v207
    s_mov_b64 exec, s[52:53]
    ds_read_b128 v[20:23], v3 offset:6144
    ds_read_b128 v[24:27], v3 offset:6656
    s_mov_b64 exec, -1
    s_add_u32 m0, s90, 2048
    s_add_u32 s59, s59, 8192
    buffer_load_dwordx4 v194, s[76:79], s59 offen lds
    v_exp_f32 v49, v49
    v_exp_f32 v50, v50
    v_exp_f32 v51, v51
    v_exp_f32 v52, v52
    v_exp_f32 v53, v53
    v_mfma_f32_32x32x16_bf16 v[64:79], v[8:11], v[4:7], v[32:47]
    ds_read_b128 v[8:11], v206 offset:8192
    v_exp_f32 v54, v54
    v_exp_f32 v55, v55
    s_setprio 1
    v_exp_f32 v56, v56
    v_exp_f32 v57, v57
    v_exp_f32 v58, v58
    v_exp_f32 v59, v59
    v_smfmac_f32_32x32x32_bf16 v[80:95], v[12:15], v[48:55], v207
    v_exp_f32 v60, v60
    v_exp_f32 v61, v61
    v_exp_f32 v62, v62
    v_exp_f32 v63, v63
    buffer_load_dwordx4 v[108:111], v2, s[32:35], s75 offen offset:1024 sc1
    s_waitcnt lgkmcnt(0)
    v_exp_f32 v64, v64
    v_smfmac_f32_32x32x32_bf16 v[80:95], v[16:19], v[56:63], v207
    s_mov_b64 exec, s[52:53]
    ds_read_b128 v[12:15], v3 offset:8192
    ds_read_b128 v[16:19], v3 offset:8704
    s_mov_b64 exec, -1
    s_add_u32 m0, s90, 3072
    s_add_u32 s59, s59, 8192
    buffer_load_dwordx4 v194, s[76:79], s59 offen lds
    v_exp_f32 v65, v65
    v_exp_f32 v66, v66
    v_exp_f32 v67, v67
    v_exp_f32 v68, v68
    v_exp_f32 v69, v69
    v_mfma_f32_32x32x16_bf16 v[48:63], v[8:11], v[4:7], v[32:47]
    ds_read_b128 v[8:11], v206 offset:10240
    v_exp_f32 v70, v70
    v_exp_f32 v71, v71
    s_setprio 0
    v_exp_f32 v72, v72
    v_exp_f32 v73, v73
    v_exp_f32 v74, v74
    v_exp_f32 v75, v75
    v_smfmac_f32_32x32x32_bf16 v[80:95], v[20:23], v[64:71], v207
    v_exp_f32 v76, v76
    v_exp_f32 v77, v77
    v_exp_f32 v78, v78
    v_exp_f32 v79, v79
    buffer_load_dwordx4 v[120:123], v2, s[32:35], s75 offen offset:2048 sc1
    s_waitcnt vmcnt(7) lgkmcnt(0)
    s_barrier
    s_setprio 3
    v_exp_f32 v48, v48
    v_smfmac_f32_32x32x32_bf16 v[80:95], v[24:27], v[72:79], v207
    s_mov_b64 exec, s[52:53]
    ds_read_b128 v[20:23], v3 offset:10240
    ds_read_b128 v[24:27], v3 offset:10752
    s_mov_b64 exec, -1
    ds_read_b64_tr_b16 v[96:97], v202 offset:0
    ds_read_b64_tr_b16 v[98:99], v202 offset:1024
    s_add_u32 m0, s80, 131072
    s_add_u32 s59, s81, 98304
    buffer_load_dwordx4 v2, s[32:35], s59 offen sc1 lds
    v_exp_f32 v49, v49
    v_exp_f32 v50, v50
    v_exp_f32 v51, v51
    v_exp_f32 v52, v52
    v_exp_f32 v53, v53
    v_mfma_f32_32x32x16_bf16 v[64:79], v[8:11], v[4:7], v[32:47]
    ds_read_b128 v[8:11], v206 offset:12288
    ds_read_b64_tr_b16 v[100:101], v203 offset:0
    ds_read_b64_tr_b16 v[102:103], v203 offset:1024
    s_lshl_b32 s90, s80, 2
    s_add_u32 m0, s90, 32768
    s_add_u32 s88, s87, 3
    s_sub_u32 s89, s88, 7
    s_cmp_ge_u32 s88, 7
    s_cselect_b32 s88, s89, s88
    s_lshl_b32 s59, s88, 18
    s_add_u32 s59, s59, s84
    buffer_load_dwordx4 v194, s[76:79], s59 offen lds
    v_exp_f32 v54, v54
    v_exp_f32 v55, v55
    v_exp_f32 v56, v56
    v_exp_f32 v57, v57
    v_exp_f32 v58, v58
    v_exp_f32 v59, v59
    v_smfmac_f32_32x32x32_bf16 v[80:95], v[12:15], v[48:55], v207
    v_exp_f32 v60, v60
    v_exp_f32 v61, v61
    v_exp_f32 v62, v62
    v_exp_f32 v63, v63
    buffer_load_dwordx4 v[124:127], v2, s[32:35], s75 offen offset:3072 sc1
    s_waitcnt vmcnt(7) lgkmcnt(0)
    v_exp_f32 v64, v64
    v_smfmac_f32_32x32x32_bf16 v[80:95], v[16:19], v[56:63], v207
    s_mov_b64 exec, s[52:53]
    ds_read_b128 v[12:15], v3 offset:12288
    ds_read_b128 v[16:19], v3 offset:12800
    s_mov_b64 exec, -1
    ds_read_b64_tr_b16 v[112:113], v202 offset:2048
    s_add_u32 m0, s90, 33792
    s_add_u32 s59, s59, 8192
    buffer_load_dwordx4 v194, s[76:79], s59 offen lds
    v_exp_f32 v65, v65
    v_exp_f32 v66, v66
    v_exp_f32 v67, v67
    v_exp_f32 v68, v68
    v_mfma_f32_32x32x16_bf16 v[48:63], v[8:11], v[4:7], v[32:47]
    ds_read_b128 v[8:11], v206 offset:14336
    ds_read_b64_tr_b16 v[114:115], v202 offset:3072
    v_exp_f32 v69, v69
    v_exp_f32 v70, v70
    v_exp_f32 v71, v71
    s_setprio 2
    v_mfma_f32_32x32x16_bf16 v[128:143], v[96:99], v[104:107], 0
    ds_read_b64_tr_b16 v[116:117], v203 offset:2048
    v_exp_f32 v72, v72
    v_exp_f32 v73, v73
    v_exp_f32 v74, v74
    v_smfmac_f32_32x32x32_bf16 v[80:95], v[20:23], v[64:71], v207
    ds_read_b64_tr_b16 v[118:119], v203 offset:3072
    v_exp_f32 v75, v75
    v_exp_f32 v76, v76
    v_exp_f32 v77, v77
    v_mfma_f32_32x32x16_bf16 v[144:159], v[100:103], v[104:107], 0
    v_exp_f32 v78, v78
    v_exp_f32 v79, v79
    s_add_u32 s88, s87, 1
    s_sub_u32 s89, s88, 7
    s_cmp_ge_u32 s88, 7
    s_cselect_b32 s88, s89, s88
    s_lshl_b32 s75, s88, 14
    s_add_u32 s75, s75, s85
    buffer_load_dwordx4 v[104:107], v2, s[32:35], s75 offen offset:0 sc1
    s_waitcnt vmcnt(7) lgkmcnt(0)
    v_exp_f32 v48, v48
    v_smfmac_f32_32x32x32_bf16 v[80:95], v[24:27], v[72:79], v207
    s_mov_b64 exec, s[52:53]
    ds_read_b128 v[20:23], v3 offset:14336
    ds_read_b128 v[24:27], v3 offset:14848
    s_mov_b64 exec, -1
    ds_read_b64_tr_b16 v[96:97], v202 offset:4096
    s_add_u32 m0, s90, 34816
    s_add_u32 s59, s59, 8192
    buffer_load_dwordx4 v194, s[76:79], s59 offen lds
    v_exp_f32 v49, v49
    v_exp_f32 v50, v50
    v_exp_f32 v51, v51
    v_exp_f32 v52, v52
    v_mfma_f32_32x32x16_bf16 v[64:79], v[8:11], v[4:7], v[32:47]
    ds_read_b128 v[8:11], v206 offset:16384
    ds_read_b64_tr_b16 v[98:99], v202 offset:5120
    v_exp_f32 v53, v53
    v_exp_f32 v54, v54
    v_exp_f32 v55, v55
    s_setprio 1
    v_mfma_f32_32x32x16_bf16 v[128:143], v[112:115], v[108:111], v[128:143]
    ds_read_b64_tr_b16 v[100:101], v203 offset:4096
    v_exp_f32 v56, v56
    v_exp_f32 v57, v57
    v_exp_f32 v58, v58
    v_smfmac_f32_32x32x32_bf16 v[80:95], v[12:15], v[48:55], v207
    ds_read_b64_tr_b16 v[102:103], v203 offset:5120
    v_exp_f32 v59, v59
    v_exp_f32 v60, v60
    v_exp_f32 v61, v61
    v_mfma_f32_32x32x16_bf16 v[144:159], v[116:119], v[108:111], v[144:159]
    v_exp_f32 v62, v62
    v_exp_f32 v63, v63
    buffer_load_dwordx4 v[108:111], v2, s[32:35], s75 offen offset:1024 sc1
    s_waitcnt vmcnt(7) lgkmcnt(0)
    v_exp_f32 v64, v64
    v_smfmac_f32_32x32x32_bf16 v[80:95], v[16:19], v[56:63], v207
    s_mov_b64 exec, s[52:53]
    ds_read_b128 v[12:15], v3 offset:16384
    ds_read_b128 v[16:19], v3 offset:16896
    s_mov_b64 exec, -1
    ds_read_b64_tr_b16 v[112:113], v202 offset:6144
    s_add_u32 m0, s90, 35840
    s_add_u32 s59, s59, 8192
    buffer_load_dwordx4 v194, s[76:79], s59 offen lds
    v_exp_f32 v65, v65
    v_exp_f32 v66, v66
    v_exp_f32 v67, v67
    v_exp_f32 v68, v68
    v_mfma_f32_32x32x16_bf16 v[48:63], v[8:11], v[4:7], v[32:47]
    ds_read_b128 v[8:11], v206 offset:18432
    ds_read_b64_tr_b16 v[114:115], v202 offset:7168
    v_exp_f32 v69, v69
    v_exp_f32 v70, v70
    v_exp_f32 v71, v71
    s_setprio 0
    v_mfma_f32_32x32x16_bf16 v[128:143], v[96:99], v[120:123], v[128:143]
    ds_read_b64_tr_b16 v[116:117], v203 offset:6144
    v_exp_f32 v72, v72
    v_exp_f32 v73, v73
    v_exp_f32 v74, v74
    v_smfmac_f32_32x32x32_bf16 v[80:95], v[20:23], v[64:71], v207
    ds_read_b64_tr_b16 v[118:119], v203 offset:7168
    v_exp_f32 v75, v75
    v_exp_f32 v76, v76
    v_exp_f32 v77, v77
    v_mfma_f32_32x32x16_bf16 v[144:159], v[100:103], v[120:123], v[144:159]
    v_exp_f32 v78, v78
    v_exp_f32 v79, v79
    buffer_load_dwordx4 v[120:123], v2, s[32:35], s75 offen offset:2048 sc1
    s_waitcnt vmcnt(8) lgkmcnt(0)
    s_barrier
    s_setprio 3
    s_waitcnt vmcnt(6) lgkmcnt(0)
    v_exp_f32 v48, v48
    v_smfmac_f32_32x32x32_bf16 v[80:95], v[24:27], v[72:79], v207
    s_mov_b64 exec, s[52:53]
    ds_read_b128 v[20:23], v3 offset:18432
    ds_read_b128 v[24:27], v3 offset:18944
    s_mov_b64 exec, -1
    ds_read_b64_tr_b16 v[96:97], v202 offset:32768
    s_add_u32 m0, s80, 139264
    s_add_u32 s59, s81, 106496
    buffer_load_dwordx4 v2, s[32:35], s59 offen sc1 lds
    v_exp_f32 v49, v49
    v_exp_f32 v50, v50
    v_exp_f32 v51, v51
    v_exp_f32 v52, v52
    v_mfma_f32_32x32x16_bf16 v[64:79], v[8:11], v[4:7], v[32:47]
    ds_read_b128 v[8:11], v206 offset:20480
    ds_read_b64_tr_b16 v[98:99], v202 offset:33792
    v_exp_f32 v53, v53
    v_exp_f32 v54, v54
    v_exp_f32 v55, v55
    v_mfma_f32_32x32x16_bf16 v[128:143], v[112:115], v[124:127], v[128:143]
    ds_read_b64_tr_b16 v[100:101], v203 offset:32768
    s_lshl_b32 s90, s80, 2
    s_add_u32 m0, s90, 65536
    s_add_u32 s88, s87, 5
    s_sub_u32 s89, s88, 7
    s_cmp_ge_u32 s88, 7
    s_cselect_b32 s88, s89, s88
    s_lshl_b32 s59, s88, 18
    s_add_u32 s59, s59, s84
    buffer_load_dwordx4 v194, s[76:79], s59 offen lds
    v_exp_f32 v56, v56
    v_exp_f32 v57, v57
    v_exp_f32 v58, v58
    v_smfmac_f32_32x32x32_bf16 v[80:95], v[12:15], v[48:55], v207
    ds_read_b64_tr_b16 v[102:103], v203 offset:33792
    v_exp_f32 v59, v59
    v_exp_f32 v60, v60
    v_exp_f32 v61, v61
    v_mfma_f32_32x32x16_bf16 v[144:159], v[116:119], v[124:127], v[144:159]
    v_exp_f32 v62, v62
    v_exp_f32 v63, v63
    buffer_load_dwordx4 v[124:127], v2, s[32:35], s75 offen offset:3072 sc1
    s_waitcnt vmcnt(7) lgkmcnt(0)
    v_exp_f32 v64, v64
    v_smfmac_f32_32x32x32_bf16 v[80:95], v[16:19], v[56:63], v207
    s_mov_b64 exec, s[52:53]
    ds_read_b128 v[12:15], v3 offset:20480
    ds_read_b128 v[16:19], v3 offset:20992
    s_mov_b64 exec, -1
    ds_read_b64_tr_b16 v[112:113], v202 offset:34816
    s_add_u32 m0, s90, 66560
    s_add_u32 s59, s59, 8192
    buffer_load_dwordx4 v194, s[76:79], s59 offen lds
    v_exp_f32 v65, v65
    v_exp_f32 v66, v66
    v_exp_f32 v67, v67
    v_exp_f32 v68, v68
    v_mfma_f32_32x32x16_bf16 v[48:63], v[8:11], v[4:7], v[32:47]
    ds_read_b128 v[8:11], v206 offset:22528
    ds_read_b64_tr_b16 v[114:115], v202 offset:35840
    v_exp_f32 v69, v69
    v_exp_f32 v70, v70
    v_exp_f32 v71, v71
    s_setprio 2
    v_mfma_f32_32x32x16_bf16 v[128:143], v[96:99], v[104:107], v[128:143]
    ds_read_b64_tr_b16 v[116:117], v203 offset:34816
    v_exp_f32 v72, v72
    v_exp_f32 v73, v73
    v_exp_f32 v74, v74
    v_smfmac_f32_32x32x32_bf16 v[80:95], v[20:23], v[64:71], v207
    ds_read_b64_tr_b16 v[118:119], v203 offset:35840
    v_exp_f32 v75, v75
    v_exp_f32 v76, v76
    v_exp_f32 v77, v77
    v_mfma_f32_32x32x16_bf16 v[144:159], v[100:103], v[104:107], v[144:159]
    v_exp_f32 v78, v78
    v_exp_f32 v79, v79
    s_add_u32 s88, s87, 2
    s_sub_u32 s89, s88, 7
    s_cmp_ge_u32 s88, 7
    s_cselect_b32 s88, s89, s88
    s_lshl_b32 s75, s88, 14
    s_add_u32 s75, s75, s85
    buffer_load_dwordx4 v[104:107], v2, s[32:35], s75 offen offset:0 sc1
    s_waitcnt vmcnt(7) lgkmcnt(0)
    v_exp_f32 v48, v48
    v_smfmac_f32_32x32x32_bf16 v[80:95], v[24:27], v[72:79], v207
    s_mov_b64 exec, s[52:53]
    ds_read_b128 v[20:23], v3 offset:22528
    ds_read_b128 v[24:27], v3 offset:23040
    s_mov_b64 exec, -1
    ds_read_b64_tr_b16 v[96:97], v202 offset:36864
    s_add_u32 m0, s90, 67584
    s_add_u32 s59, s59, 8192
    buffer_load_dwordx4 v194, s[76:79], s59 offen lds
    v_exp_f32 v49, v49
    v_exp_f32 v50, v50
    v_exp_f32 v51, v51
    v_exp_f32 v52, v52
    v_mfma_f32_32x32x16_bf16 v[64:79], v[8:11], v[4:7], v[32:47]
    ds_read_b128 v[8:11], v206 offset:0
    ds_read_b64_tr_b16 v[98:99], v202 offset:37888
    v_exp_f32 v53, v53
    v_exp_f32 v54, v54
    v_exp_f32 v55, v55
    s_setprio 1
    v_mfma_f32_32x32x16_bf16 v[128:143], v[112:115], v[108:111], v[128:143]
    ds_read_b64_tr_b16 v[100:101], v203 offset:36864
    v_exp_f32 v56, v56
    v_exp_f32 v57, v57
    v_exp_f32 v58, v58
    v_smfmac_f32_32x32x32_bf16 v[80:95], v[12:15], v[48:55], v207
    ds_read_b64_tr_b16 v[102:103], v203 offset:37888
    v_exp_f32 v59, v59
    v_exp_f32 v60, v60
    v_exp_f32 v61, v61
    v_mfma_f32_32x32x16_bf16 v[144:159], v[116:119], v[108:111], v[144:159]
    v_exp_f32 v62, v62
    v_exp_f32 v63, v63
    buffer_load_dwordx4 v[108:111], v2, s[32:35], s75 offen offset:1024 sc1
    s_waitcnt vmcnt(7) lgkmcnt(0)
    v_exp_f32 v64, v64
    v_smfmac_f32_32x32x32_bf16 v[80:95], v[16:19], v[56:63], v207
    s_mov_b64 exec, s[52:53]
    ds_read_b128 v[12:15], v3 offset:0
    ds_read_b128 v[16:19], v3 offset:512
    s_mov_b64 exec, -1
    ds_read_b64_tr_b16 v[112:113], v202 offset:38912
    s_add_u32 m0, s90, 68608
    s_add_u32 s59, s59, 8192
    buffer_load_dwordx4 v194, s[76:79], s59 offen lds
    v_exp_f32 v65, v65
    v_exp_f32 v66, v66
    v_exp_f32 v67, v67
    v_exp_f32 v68, v68
    v_mfma_f32_32x32x16_bf16 v[48:63], v[8:11], v[4:7], v[32:47]
    ds_read_b128 v[8:11], v206 offset:2048
    ds_read_b64_tr_b16 v[114:115], v202 offset:39936
    v_exp_f32 v69, v69
    v_exp_f32 v70, v70
    v_exp_f32 v71, v71
    s_setprio 0
    v_mfma_f32_32x32x16_bf16 v[128:143], v[96:99], v[120:123], v[128:143]
    ds_read_b64_tr_b16 v[116:117], v203 offset:38912
    v_exp_f32 v72, v72
    v_exp_f32 v73, v73
    v_exp_f32 v74, v74
    v_smfmac_f32_32x32x32_bf16 v[80:95], v[20:23], v[64:71], v207
    ds_read_b64_tr_b16 v[118:119], v203 offset:39936
    v_exp_f32 v75, v75
    v_exp_f32 v76, v76
    v_exp_f32 v77, v77
    v_mfma_f32_32x32x16_bf16 v[144:159], v[100:103], v[120:123], v[144:159]
    v_exp_f32 v78, v78
    v_exp_f32 v79, v79
    buffer_load_dwordx4 v[120:123], v2, s[32:35], s75 offen offset:2048 sc1
    s_waitcnt vmcnt(8) lgkmcnt(0)
    s_barrier
    s_setprio 3
    s_waitcnt vmcnt(6) lgkmcnt(0)
    v_exp_f32 v48, v48
    v_smfmac_f32_32x32x32_bf16 v[80:95], v[24:27], v[72:79], v207
    s_mov_b64 exec, s[52:53]
    ds_read_b128 v[20:23], v3 offset:2048
    ds_read_b128 v[24:27], v3 offset:2560
    s_mov_b64 exec, -1
    ds_read_b64_tr_b16 v[96:97], v204 offset:0
    s_add_u32 m0, s80, 147456
    s_add_u32 s59, s81, 114688
    buffer_load_dwordx4 v2, s[32:35], s59 offen sc1 lds
    v_exp_f32 v49, v49
    v_exp_f32 v50, v50
    v_exp_f32 v51, v51
    v_exp_f32 v52, v52
    v_mfma_f32_32x32x16_bf16 v[64:79], v[8:11], v[4:7], v[32:47]
    ds_read_b128 v[8:11], v206 offset:4096
    ds_read_b64_tr_b16 v[98:99], v204 offset:1024
    v_exp_f32 v53, v53
    v_exp_f32 v54, v54
    v_exp_f32 v55, v55
    v_mfma_f32_32x32x16_bf16 v[128:143], v[112:115], v[124:127], v[128:143]
    ds_read_b64_tr_b16 v[100:101], v205 offset:0
    s_lshl_b32 s90, s80, 2
    s_add_u32 m0, s90, 98304
    s_add_u32 s88, s87, 6
    s_sub_u32 s89, s88, 7
    s_cmp_ge_u32 s88, 7
    s_cselect_b32 s88, s89, s88
    s_lshl_b32 s59, s88, 18
    s_add_u32 s59, s59, s84
    buffer_load_dwordx4 v194, s[76:79], s59 offen lds
    v_exp_f32 v56, v56
    v_exp_f32 v57, v57
    v_exp_f32 v58, v58
    v_smfmac_f32_32x32x32_bf16 v[80:95], v[12:15], v[48:55], v207
    ds_read_b64_tr_b16 v[102:103], v205 offset:1024
    v_exp_f32 v59, v59
    v_exp_f32 v60, v60
    v_exp_f32 v61, v61
    v_mfma_f32_32x32x16_bf16 v[144:159], v[116:119], v[124:127], v[144:159]
    v_exp_f32 v62, v62
    v_exp_f32 v63, v63
    buffer_load_dwordx4 v[124:127], v2, s[32:35], s75 offen offset:3072 sc1
    s_waitcnt vmcnt(7) lgkmcnt(0)
    v_exp_f32 v64, v64
    v_smfmac_f32_32x32x32_bf16 v[80:95], v[16:19], v[56:63], v207
    s_mov_b64 exec, s[52:53]
    ds_read_b128 v[12:15], v3 offset:4096
    ds_read_b128 v[16:19], v3 offset:4608
    s_mov_b64 exec, -1
    ds_read_b64_tr_b16 v[112:113], v204 offset:2048
    s_add_u32 m0, s90, 99328
    s_add_u32 s59, s59, 8192
    buffer_load_dwordx4 v194, s[76:79], s59 offen lds
    v_exp_f32 v65, v65
    v_exp_f32 v66, v66
    v_exp_f32 v67, v67
    v_exp_f32 v68, v68
    v_mfma_f32_32x32x16_bf16 v[48:63], v[8:11], v[4:7], v[32:47]
    ds_read_b128 v[8:11], v206 offset:6144
    ds_read_b64_tr_b16 v[114:115], v204 offset:3072
    v_exp_f32 v69, v69
    v_exp_f32 v70, v70
    v_exp_f32 v71, v71
    s_setprio 2
    v_mfma_f32_32x32x16_bf16 v[128:143], v[96:99], v[104:107], v[128:143]
    ds_read_b64_tr_b16 v[116:117], v205 offset:2048
    v_exp_f32 v72, v72
    v_exp_f32 v73, v73
    v_exp_f32 v74, v74
    v_smfmac_f32_32x32x32_bf16 v[80:95], v[20:23], v[64:71], v207
    ds_read_b64_tr_b16 v[118:119], v205 offset:3072
    v_exp_f32 v75, v75
    v_exp_f32 v76, v76
    v_exp_f32 v77, v77
    v_mfma_f32_32x32x16_bf16 v[144:159], v[100:103], v[104:107], v[144:159]
    v_exp_f32 v78, v78
    v_exp_f32 v79, v79
    s_add_u32 s88, s87, 3
    s_sub_u32 s89, s88, 7
    s_cmp_ge_u32 s88, 7
    s_cselect_b32 s88, s89, s88
    s_lshl_b32 s75, s88, 14
    s_add_u32 s75, s75, s85
    buffer_load_dwordx4 v[104:107], v2, s[32:35], s75 offen offset:0 sc1
    s_waitcnt vmcnt(7) lgkmcnt(0)
    v_exp_f32 v48, v48
    v_smfmac_f32_32x32x32_bf16 v[80:95], v[24:27], v[72:79], v207
    s_mov_b64 exec, s[52:53]
    ds_read_b128 v[20:23], v3 offset:6144
    ds_read_b128 v[24:27], v3 offset:6656
    s_mov_b64 exec, -1
    ds_read_b64_tr_b16 v[96:97], v204 offset:4096
    s_add_u32 m0, s90, 100352
    s_add_u32 s59, s59, 8192
    buffer_load_dwordx4 v194, s[76:79], s59 offen lds
    v_exp_f32 v49, v49
    v_exp_f32 v50, v50
    v_exp_f32 v51, v51
    v_exp_f32 v52, v52
    v_mfma_f32_32x32x16_bf16 v[64:79], v[8:11], v[4:7], v[32:47]
    ds_read_b128 v[8:11], v206 offset:8192
    ds_read_b64_tr_b16 v[98:99], v204 offset:5120
    v_exp_f32 v53, v53
    v_exp_f32 v54, v54
    v_exp_f32 v55, v55
    s_setprio 1
    v_mfma_f32_32x32x16_bf16 v[128:143], v[112:115], v[108:111], v[128:143]
    ds_read_b64_tr_b16 v[100:101], v205 offset:4096
    v_exp_f32 v56, v56
    v_exp_f32 v57, v57
    v_exp_f32 v58, v58
    v_smfmac_f32_32x32x32_bf16 v[80:95], v[12:15], v[48:55], v207
    ds_read_b64_tr_b16 v[102:103], v205 offset:5120
    v_exp_f32 v59, v59
    v_exp_f32 v60, v60
    v_exp_f32 v61, v61
    v_mfma_f32_32x32x16_bf16 v[144:159], v[116:119], v[108:111], v[144:159]
    v_exp_f32 v62, v62
    v_exp_f32 v63, v63
    buffer_load_dwordx4 v[108:111], v2, s[32:35], s75 offen offset:1024 sc1
    s_waitcnt vmcnt(7) lgkmcnt(0)
    v_exp_f32 v64, v64
    v_smfmac_f32_32x32x32_bf16 v[80:95], v[16:19], v[56:63], v207
    s_mov_b64 exec, s[52:53]
    ds_read_b128 v[12:15], v3 offset:8192
    ds_read_b128 v[16:19], v3 offset:8704
    s_mov_b64 exec, -1
    ds_read_b64_tr_b16 v[112:113], v204 offset:6144
    s_add_u32 m0, s90, 101376
    s_add_u32 s59, s59, 8192
    buffer_load_dwordx4 v194, s[76:79], s59 offen lds
    v_exp_f32 v65, v65
    v_exp_f32 v66, v66
    v_exp_f32 v67, v67
    v_exp_f32 v68, v68
    v_mfma_f32_32x32x16_bf16 v[48:63], v[8:11], v[4:7], v[32:47]
    ds_read_b128 v[8:11], v206 offset:10240
    ds_read_b64_tr_b16 v[114:115], v204 offset:7168
    v_exp_f32 v69, v69
    v_exp_f32 v70, v70
    v_exp_f32 v71, v71
    s_setprio 0
    v_mfma_f32_32x32x16_bf16 v[128:143], v[96:99], v[120:123], v[128:143]
    ds_read_b64_tr_b16 v[116:117], v205 offset:6144
    v_exp_f32 v72, v72
    v_exp_f32 v73, v73
    v_exp_f32 v74, v74
    v_smfmac_f32_32x32x32_bf16 v[80:95], v[20:23], v[64:71], v207
    ds_read_b64_tr_b16 v[118:119], v205 offset:7168
    v_exp_f32 v75, v75
    v_exp_f32 v76, v76
    v_exp_f32 v77, v77
    v_mfma_f32_32x32x16_bf16 v[144:159], v[100:103], v[120:123], v[144:159]
    v_exp_f32 v78, v78
    v_exp_f32 v79, v79
    buffer_load_dwordx4 v[120:123], v2, s[32:35], s75 offen offset:2048 sc1
    s_waitcnt vmcnt(8) lgkmcnt(0)
    s_barrier
    s_setprio 3
    s_waitcnt vmcnt(6) lgkmcnt(0)
    v_exp_f32 v48, v48
    v_smfmac_f32_32x32x32_bf16 v[80:95], v[24:27], v[72:79], v207
    s_mov_b64 exec, s[52:53]
    ds_read_b128 v[20:23], v3 offset:10240
    ds_read_b128 v[24:27], v3 offset:10752
    s_mov_b64 exec, -1
    ds_read_b64_tr_b16 v[96:97], v204 offset:32768
    s_add_u32 m0, s80, 131072
    s_add_u32 s59, s81, 122880
    buffer_load_dwordx4 v2, s[32:35], s59 offen sc1 lds
    v_exp_f32 v49, v49
    v_exp_f32 v50, v50
    v_exp_f32 v51, v51
    v_exp_f32 v52, v52
    v_mfma_f32_32x32x16_bf16 v[64:79], v[8:11], v[4:7], v[32:47]
    ds_read_b128 v[8:11], v206 offset:12288
    ds_read_b64_tr_b16 v[98:99], v204 offset:33792
    v_exp_f32 v53, v53
    v_exp_f32 v54, v54
    v_exp_f32 v55, v55
    v_mfma_f32_32x32x16_bf16 v[128:143], v[112:115], v[124:127], v[128:143]
    ds_read_b64_tr_b16 v[100:101], v205 offset:32768
    s_lshl_b32 s90, s80, 2
    s_add_u32 m0, s90, 0
    s_add_u32 s88, s87, 4
    s_sub_u32 s89, s88, 7
    s_cmp_ge_u32 s88, 7
    s_cselect_b32 s88, s89, s88
    s_lshl_b32 s59, s88, 18
    s_add_u32 s59, s59, s84
    buffer_load_dwordx4 v194, s[76:79], s59 offen lds
    v_exp_f32 v56, v56
    v_exp_f32 v57, v57
    v_exp_f32 v58, v58
    v_smfmac_f32_32x32x32_bf16 v[80:95], v[12:15], v[48:55], v207
    ds_read_b64_tr_b16 v[102:103], v205 offset:33792
    v_exp_f32 v59, v59
    v_exp_f32 v60, v60
    v_exp_f32 v61, v61
    v_mfma_f32_32x32x16_bf16 v[144:159], v[116:119], v[124:127], v[144:159]
    v_exp_f32 v62, v62
    v_exp_f32 v63, v63
    buffer_load_dwordx4 v[124:127], v2, s[32:35], s75 offen offset:3072 sc1
    s_waitcnt vmcnt(7) lgkmcnt(0)
    v_exp_f32 v64, v64
    v_smfmac_f32_32x32x32_bf16 v[80:95], v[16:19], v[56:63], v207
    s_mov_b64 exec, s[52:53]
    ds_read_b128 v[12:15], v3 offset:12288
    ds_read_b128 v[16:19], v3 offset:12800
    s_mov_b64 exec, -1
    ds_read_b64_tr_b16 v[112:113], v204 offset:34816
    s_add_u32 m0, s90, 1024
    s_add_u32 s59, s59, 8192
    buffer_load_dwordx4 v194, s[76:79], s59 offen lds
    v_exp_f32 v65, v65
    v_exp_f32 v66, v66
    v_exp_f32 v67, v67
    v_exp_f32 v68, v68
    v_mfma_f32_32x32x16_bf16 v[48:63], v[8:11], v[4:7], v[32:47]
    ds_read_b128 v[8:11], v206 offset:14336
    ds_read_b64_tr_b16 v[114:115], v204 offset:35840
    v_exp_f32 v69, v69
    v_exp_f32 v70, v70
    v_exp_f32 v71, v71
    s_setprio 2
    v_mfma_f32_32x32x16_bf16 v[128:143], v[96:99], v[104:107], v[128:143]
    ds_read_b64_tr_b16 v[116:117], v205 offset:34816
    s_add_u32 m0, s90, 2048
    s_add_u32 s59, s59, 8192
    buffer_load_dwordx4 v194, s[76:79], s59 offen lds
    v_exp_f32 v72, v72
    v_exp_f32 v73, v73
    v_exp_f32 v74, v74
    v_smfmac_f32_32x32x32_bf16 v[80:95], v[20:23], v[64:71], v207
    ds_read_b64_tr_b16 v[118:119], v205 offset:35840
    v_exp_f32 v75, v75
    v_exp_f32 v76, v76
    v_exp_f32 v77, v77
    v_mfma_f32_32x32x16_bf16 v[144:159], v[100:103], v[104:107], v[144:159]
    v_exp_f32 v78, v78
    v_exp_f32 v79, v79
    s_add_u32 s88, s87, 4
    s_sub_u32 s89, s88, 7
    s_cmp_ge_u32 s88, 7
    s_cselect_b32 s88, s89, s88
    s_lshl_b32 s75, s88, 14
    s_add_u32 s75, s75, s85
    buffer_load_dwordx4 v[104:107], v2, s[32:35], s75 offen offset:0 sc1
    s_waitcnt vmcnt(8) lgkmcnt(0)
    v_exp_f32 v48, v48
    v_smfmac_f32_32x32x32_bf16 v[80:95], v[24:27], v[72:79], v207
    s_mov_b64 exec, s[52:53]
    ds_read_b128 v[20:23], v3 offset:14336
    ds_read_b128 v[24:27], v3 offset:14848
    s_mov_b64 exec, -1
    ds_read_b64_tr_b16 v[96:97], v204 offset:36864
    s_add_u32 m0, s90, 3072
    s_add_u32 s59, s59, 8192
    buffer_load_dwordx4 v194, s[76:79], s59 offen lds
    v_exp_f32 v49, v49
    v_exp_f32 v50, v50
    v_exp_f32 v51, v51
    v_exp_f32 v52, v52
    v_mfma_f32_32x32x16_bf16 v[64:79], v[8:11], v[4:7], v[32:47]
    ds_read_b128 v[8:11], v206 offset:16384
    ds_read_b64_tr_b16 v[98:99], v204 offset:37888
    v_exp_f32 v53, v53
    v_exp_f32 v54, v54
    v_exp_f32 v55, v55
    s_setprio 1
    v_mfma_f32_32x32x16_bf16 v[128:143], v[112:115], v[108:111], v[128:143]
    ds_read_b64_tr_b16 v[100:101], v205 offset:36864
    v_exp_f32 v56, v56
    v_exp_f32 v57, v57
    v_exp_f32 v58, v58
    v_smfmac_f32_32x32x32_bf16 v[80:95], v[12:15], v[48:55], v207
    ds_read_b64_tr_b16 v[102:103], v205 offset:37888
    v_exp_f32 v59, v59
    v_exp_f32 v60, v60
    v_exp_f32 v61, v61
    v_mfma_f32_32x32x16_bf16 v[144:159], v[116:119], v[108:111], v[144:159]
    v_exp_f32 v62, v62
    v_exp_f32 v63, v63
    buffer_load_dwordx4 v[108:111], v2, s[32:35], s75 offen offset:1024 sc1
    s_waitcnt vmcnt(8) lgkmcnt(0)
    v_exp_f32 v64, v64
    v_smfmac_f32_32x32x32_bf16 v[80:95], v[16:19], v[56:63], v207
    s_mov_b64 exec, s[52:53]
    ds_read_b128 v[12:15], v3 offset:16384
    ds_read_b128 v[16:19], v3 offset:16896
    s_mov_b64 exec, -1
    ds_read_b64_tr_b16 v[112:113], v204 offset:38912
    v_exp_f32 v65, v65
    v_exp_f32 v66, v66
    v_exp_f32 v67, v67
    v_exp_f32 v68, v68
    v_mfma_f32_32x32x16_bf16 v[48:63], v[8:11], v[4:7], v[32:47]
    ds_read_b128 v[8:11], v206 offset:18432
    ds_read_b64_tr_b16 v[114:115], v204 offset:39936
    v_exp_f32 v69, v69
    v_exp_f32 v70, v70
    v_exp_f32 v71, v71
    s_setprio 0
    v_mfma_f32_32x32x16_bf16 v[128:143], v[96:99], v[120:123], v[128:143]
    ds_read_b64_tr_b16 v[116:117], v205 offset:38912
    v_exp_f32 v72, v72
    v_exp_f32 v73, v73
    v_exp_f32 v74, v74
    v_smfmac_f32_32x32x32_bf16 v[80:95], v[20:23], v[64:71], v207
    ds_read_b64_tr_b16 v[118:119], v205 offset:39936
    v_exp_f32 v75, v75
    v_exp_f32 v76, v76
    v_exp_f32 v77, v77
    v_mfma_f32_32x32x16_bf16 v[144:159], v[100:103], v[120:123], v[144:159]
    v_exp_f32 v78, v78
    v_exp_f32 v79, v79
    buffer_load_dwordx4 v[120:123], v2, s[32:35], s75 offen offset:2048 sc1
    s_waitcnt vmcnt(2) lgkmcnt(0)
    s_barrier
    s_setprio 3
    s_waitcnt vmcnt(6) lgkmcnt(0)
    v_exp_f32 v48, v48
    v_smfmac_f32_32x32x32_bf16 v[80:95], v[24:27], v[72:79], v207
    s_mov_b64 exec, s[52:53]
    ds_read_b128 v[20:23], v3 offset:18432
    ds_read_b128 v[24:27], v3 offset:18944
    s_mov_b64 exec, -1
    ds_read_b64_tr_b16 v[96:97], v204 offset:0
    s_lshl_b32 s57, s43, 16
    s_lshl_b32 s68, s40, 13
    s_add_u32 s57, s57, s68
    s_lshl_b32 s68, s44, 7
    s_add_u32 s57, s57, s68
    v_lshrrev_b32 v228, 3, v0
    v_lshlrev_b32 v228, 10, v228
    v_and_b32 v229, 7, v0
    v_lshl_add_u32 v228, v229, 4, v228
    buffer_load_dwordx4 v[224:227], v228, s[16:19], s57 offen
    v_exp_f32 v49, v49
    v_exp_f32 v50, v50
    v_exp_f32 v51, v51
    v_exp_f32 v52, v52
    v_mfma_f32_32x32x16_bf16 v[64:79], v[8:11], v[4:7], v[32:47]
    ds_read_b128 v[8:11], v206 offset:20480
    ds_read_b64_tr_b16 v[98:99], v204 offset:1024
    v_exp_f32 v53, v53
    v_exp_f32 v54, v54
    v_exp_f32 v55, v55
    v_mfma_f32_32x32x16_bf16 v[128:143], v[112:115], v[124:127], v[128:143]
    ds_read_b64_tr_b16 v[100:101], v205 offset:0
    v_exp_f32 v56, v56
    v_exp_f32 v57, v57
    v_exp_f32 v58, v58
    v_smfmac_f32_32x32x32_bf16 v[80:95], v[12:15], v[48:55], v207
    ds_read_b64_tr_b16 v[102:103], v205 offset:1024
    v_exp_f32 v59, v59
    v_exp_f32 v60, v60
    v_exp_f32 v61, v61
    v_mfma_f32_32x32x16_bf16 v[144:159], v[116:119], v[124:127], v[144:159]
    v_exp_f32 v62, v62
    v_exp_f32 v63, v63
    buffer_load_dwordx4 v[124:127], v2, s[32:35], s75 offen offset:3072 sc1
    s_waitcnt vmcnt(5) lgkmcnt(0)
    v_exp_f32 v64, v64
    v_smfmac_f32_32x32x32_bf16 v[80:95], v[16:19], v[56:63], v207
    s_mov_b64 exec, s[52:53]
    ds_read_b128 v[12:15], v3 offset:20480
    ds_read_b128 v[16:19], v3 offset:20992
    s_mov_b64 exec, -1
    ds_read_b64_tr_b16 v[112:113], v204 offset:2048
    v_exp_f32 v65, v65
    v_exp_f32 v66, v66
    v_exp_f32 v67, v67
    v_exp_f32 v68, v68
    v_mfma_f32_32x32x16_bf16 v[48:63], v[8:11], v[4:7], v[32:47]
    ds_read_b128 v[8:11], v206 offset:22528
    ds_read_b64_tr_b16 v[114:115], v204 offset:3072
    v_exp_f32 v69, v69
    v_exp_f32 v70, v70
    v_exp_f32 v71, v71
    s_setprio 2
    v_mfma_f32_32x32x16_bf16 v[128:143], v[96:99], v[104:107], v[128:143]
    ds_read_b64_tr_b16 v[116:117], v205 offset:2048
    v_exp_f32 v72, v72
    v_exp_f32 v73, v73
    v_exp_f32 v74, v74
    v_smfmac_f32_32x32x32_bf16 v[80:95], v[20:23], v[64:71], v207
    ds_read_b64_tr_b16 v[118:119], v205 offset:3072
    v_exp_f32 v75, v75
    v_exp_f32 v76, v76
    v_exp_f32 v77, v77
    v_mfma_f32_32x32x16_bf16 v[144:159], v[100:103], v[104:107], v[144:159]
    v_exp_f32 v78, v78
    v_exp_f32 v79, v79
    s_add_u32 s88, s87, 5
    s_sub_u32 s89, s88, 7
    s_cmp_ge_u32 s88, 7
    s_cselect_b32 s88, s89, s88
    s_lshl_b32 s75, s88, 14
    s_add_u32 s75, s75, s85
    buffer_load_dwordx4 v[104:107], v2, s[32:35], s75 offen offset:0 sc1
    s_waitcnt vmcnt(4) lgkmcnt(0)
    v_exp_f32 v48, v48
    v_smfmac_f32_32x32x32_bf16 v[80:95], v[24:27], v[72:79], v207
    s_mov_b64 exec, s[52:53]
    ds_read_b128 v[20:23], v3 offset:22528
    ds_read_b128 v[24:27], v3 offset:23040
    s_mov_b64 exec, -1
    ds_read_b64_tr_b16 v[96:97], v204 offset:4096
    v_exp_f32 v49, v49
    v_exp_f32 v50, v50
    v_exp_f32 v51, v51
    v_exp_f32 v52, v52
    v_mfma_f32_32x32x16_bf16 v[64:79], v[8:11], v[4:7], v[32:47]
    ds_read_b128 v[8:11], v206 offset:0
    ds_read_b64_tr_b16 v[98:99], v204 offset:5120
    v_exp_f32 v53, v53
    v_exp_f32 v54, v54
    v_exp_f32 v55, v55
    s_setprio 1
    v_mfma_f32_32x32x16_bf16 v[128:143], v[112:115], v[108:111], v[128:143]
    ds_read_b64_tr_b16 v[100:101], v205 offset:4096
    v_exp_f32 v56, v56
    v_exp_f32 v57, v57
    v_exp_f32 v58, v58
    v_smfmac_f32_32x32x32_bf16 v[80:95], v[12:15], v[48:55], v207
    ds_read_b64_tr_b16 v[102:103], v205 offset:5120
    v_exp_f32 v59, v59
    v_exp_f32 v60, v60
    v_exp_f32 v61, v61
    v_mfma_f32_32x32x16_bf16 v[144:159], v[116:119], v[108:111], v[144:159]
    v_exp_f32 v62, v62
    v_exp_f32 v63, v63
    buffer_load_dwordx4 v[108:111], v2, s[32:35], s75 offen offset:1024 sc1
    s_waitcnt vmcnt(4) lgkmcnt(0)
    v_exp_f32 v64, v64
    v_smfmac_f32_32x32x32_bf16 v[80:95], v[16:19], v[56:63], v207
    s_mov_b64 exec, s[52:53]
    ds_read_b128 v[12:15], v3 offset:0
    ds_read_b128 v[16:19], v3 offset:512
    s_mov_b64 exec, -1
    ds_read_b64_tr_b16 v[112:113], v204 offset:6144
    v_exp_f32 v65, v65
    v_exp_f32 v66, v66
    v_exp_f32 v67, v67
    v_exp_f32 v68, v68
    v_mfma_f32_32x32x16_bf16 v[48:63], v[8:11], v[4:7], v[32:47]
    ds_read_b128 v[8:11], v206 offset:2048
    ds_read_b64_tr_b16 v[114:115], v204 offset:7168
    v_exp_f32 v69, v69
    v_exp_f32 v70, v70
    v_exp_f32 v71, v71
    s_setprio 0
    v_mfma_f32_32x32x16_bf16 v[128:143], v[96:99], v[120:123], v[128:143]
    ds_read_b64_tr_b16 v[116:117], v205 offset:6144
    v_exp_f32 v72, v72
    v_exp_f32 v73, v73
    v_exp_f32 v74, v74
    v_smfmac_f32_32x32x32_bf16 v[80:95], v[20:23], v[64:71], v207
    ds_read_b64_tr_b16 v[118:119], v205 offset:7168
    v_exp_f32 v75, v75
    v_exp_f32 v76, v76
    v_exp_f32 v77, v77
    v_mfma_f32_32x32x16_bf16 v[144:159], v[100:103], v[120:123], v[144:159]
    v_exp_f32 v78, v78
    v_exp_f32 v79, v79
    buffer_load_dwordx4 v[120:123], v2, s[32:35], s75 offen offset:2048 sc1
    s_waitcnt vmcnt(15) lgkmcnt(0)
    s_barrier
    s_setprio 3
    s_waitcnt vmcnt(3) lgkmcnt(0)
    v_exp_f32 v48, v48
    v_smfmac_f32_32x32x32_bf16 v[80:95], v[24:27], v[72:79], v207
    s_mov_b64 exec, s[52:53]
    ds_read_b128 v[20:23], v3 offset:2048
    ds_read_b128 v[24:27], v3 offset:2560
    s_mov_b64 exec, -1
    ds_read_b64_tr_b16 v[96:97], v202 offset:0
    v_exp_f32 v49, v49
    v_exp_f32 v50, v50
    v_exp_f32 v51, v51
    v_exp_f32 v52, v52
    v_mfma_f32_32x32x16_bf16 v[64:79], v[8:11], v[4:7], v[32:47]
    ds_read_b128 v[8:11], v206 offset:4096
    ds_read_b64_tr_b16 v[98:99], v202 offset:1024
    v_exp_f32 v53, v53
    v_exp_f32 v54, v54
    v_exp_f32 v55, v55
    v_mfma_f32_32x32x16_bf16 v[128:143], v[112:115], v[124:127], v[128:143]
    ds_read_b64_tr_b16 v[100:101], v203 offset:0
    v_exp_f32 v56, v56
    v_exp_f32 v57, v57
    v_exp_f32 v58, v58
    v_smfmac_f32_32x32x32_bf16 v[80:95], v[12:15], v[48:55], v207
    ds_read_b64_tr_b16 v[102:103], v203 offset:1024
    v_exp_f32 v59, v59
    v_exp_f32 v60, v60
    v_exp_f32 v61, v61
    v_mfma_f32_32x32x16_bf16 v[144:159], v[116:119], v[124:127], v[144:159]
    v_exp_f32 v62, v62
    v_exp_f32 v63, v63
    buffer_load_dwordx4 v[124:127], v2, s[32:35], s75 offen offset:3072 sc1
    s_waitcnt vmcnt(3) lgkmcnt(0)
    v_exp_f32 v64, v64
    v_smfmac_f32_32x32x32_bf16 v[80:95], v[16:19], v[56:63], v207
    s_mov_b64 exec, s[52:53]
    ds_read_b128 v[12:15], v3 offset:4096
    ds_read_b128 v[16:19], v3 offset:4608
    s_mov_b64 exec, -1
    ds_read_b64_tr_b16 v[112:113], v202 offset:2048
    v_exp_f32 v65, v65
    v_exp_f32 v66, v66
    v_exp_f32 v67, v67
    v_exp_f32 v68, v68
    v_mfma_f32_32x32x16_bf16 v[48:63], v[8:11], v[4:7], v[32:47]
    ds_read_b128 v[8:11], v206 offset:6144
    ds_read_b64_tr_b16 v[114:115], v202 offset:3072
    v_exp_f32 v69, v69
    v_exp_f32 v70, v70
    v_exp_f32 v71, v71
    s_setprio 2
    v_mfma_f32_32x32x16_bf16 v[128:143], v[96:99], v[104:107], v[128:143]
    ds_read_b64_tr_b16 v[116:117], v203 offset:2048
    v_exp_f32 v72, v72
    v_exp_f32 v73, v73
    v_exp_f32 v74, v74
    v_smfmac_f32_32x32x32_bf16 v[80:95], v[20:23], v[64:71], v207
    ds_read_b64_tr_b16 v[118:119], v203 offset:3072
    v_exp_f32 v75, v75
    v_exp_f32 v76, v76
    v_exp_f32 v77, v77
    v_mfma_f32_32x32x16_bf16 v[144:159], v[100:103], v[104:107], v[144:159]
    v_exp_f32 v78, v78
    v_exp_f32 v79, v79
    s_add_u32 s88, s87, 6
    s_sub_u32 s89, s88, 7
    s_cmp_ge_u32 s88, 7
    s_cselect_b32 s88, s89, s88
    s_lshl_b32 s75, s88, 14
    s_add_u32 s75, s75, s85
    buffer_load_dwordx4 v[104:107], v2, s[32:35], s75 offen offset:0 sc1
    s_waitcnt vmcnt(3) lgkmcnt(0)
    v_exp_f32 v48, v48
    v_smfmac_f32_32x32x32_bf16 v[80:95], v[24:27], v[72:79], v207
    s_mov_b64 exec, s[52:53]
    ds_read_b128 v[20:23], v3 offset:6144
    ds_read_b128 v[24:27], v3 offset:6656
    s_mov_b64 exec, -1
    ds_read_b64_tr_b16 v[96:97], v202 offset:4096
    v_exp_f32 v49, v49
    v_exp_f32 v50, v50
    v_exp_f32 v51, v51
    v_exp_f32 v52, v52
    v_mfma_f32_32x32x16_bf16 v[64:79], v[8:11], v[4:7], v[32:47]
    ds_read_b64_tr_b16 v[98:99], v202 offset:5120
    v_exp_f32 v53, v53
    v_exp_f32 v54, v54
    v_exp_f32 v55, v55
    s_setprio 1
    v_mfma_f32_32x32x16_bf16 v[128:143], v[112:115], v[108:111], v[128:143]
    ds_read_b64_tr_b16 v[100:101], v203 offset:4096
    v_exp_f32 v56, v56
    v_exp_f32 v57, v57
    v_exp_f32 v58, v58
    v_smfmac_f32_32x32x32_bf16 v[80:95], v[12:15], v[48:55], v207
    ds_read_b64_tr_b16 v[102:103], v203 offset:5120
    v_exp_f32 v59, v59
    v_exp_f32 v60, v60
    v_exp_f32 v61, v61
    v_mfma_f32_32x32x16_bf16 v[144:159], v[116:119], v[108:111], v[144:159]
    v_exp_f32 v62, v62
    v_exp_f32 v63, v63
    buffer_load_dwordx4 v[108:111], v2, s[32:35], s75 offen offset:1024 sc1
    s_waitcnt vmcnt(3) lgkmcnt(0)
    v_exp_f32 v64, v64
    v_smfmac_f32_32x32x32_bf16 v[80:95], v[16:19], v[56:63], v207
    ds_read_b64_tr_b16 v[112:113], v202 offset:6144
    v_exp_f32 v65, v65
    v_exp_f32 v66, v66
    v_exp_f32 v67, v67
    v_exp_f32 v68, v68
    ds_read_b64_tr_b16 v[114:115], v202 offset:7168
    v_exp_f32 v69, v69
    v_exp_f32 v70, v70
    v_exp_f32 v71, v71
    s_setprio 0
    v_mfma_f32_32x32x16_bf16 v[128:143], v[96:99], v[120:123], v[128:143]
    ds_read_b64_tr_b16 v[116:117], v203 offset:6144
    v_exp_f32 v72, v72
    v_exp_f32 v73, v73
    v_exp_f32 v74, v74
    v_smfmac_f32_32x32x32_bf16 v[80:95], v[20:23], v[64:71], v207
    ds_read_b64_tr_b16 v[118:119], v203 offset:7168
    v_exp_f32 v75, v75
    v_exp_f32 v76, v76
    v_exp_f32 v77, v77
    v_mfma_f32_32x32x16_bf16 v[144:159], v[100:103], v[120:123], v[144:159]
    v_exp_f32 v78, v78
    v_exp_f32 v79, v79
    buffer_load_dwordx4 v[120:123], v2, s[32:35], s75 offen offset:2048 sc1
    s_waitcnt lgkmcnt(0)
    s_nop 0
    v_smfmac_f32_32x32x32_bf16 v[80:95], v[24:27], v[72:79], v207
    s_waitcnt vmcnt(3)
    v_mfma_f32_32x32x16_bf16 v[128:143], v[112:115], v[124:127], v[128:143]
    v_mfma_f32_32x32x16_bf16 v[144:159], v[116:119], v[124:127], v[144:159]
    buffer_load_dwordx4 v[124:127], v2, s[32:35], s75 offen offset:3072 sc1
    ds_read_b64_tr_b16 v[96:97], v202 offset:32768
    ds_read_b64_tr_b16 v[98:99], v202 offset:33792
    ds_read_b64_tr_b16 v[100:101], v203 offset:32768
    ds_read_b64_tr_b16 v[102:103], v203 offset:33792
    s_lshl_b32 s59, s45, 5
    s_add_u32 s59, s59, s43
    s_lshl_b32 s59, s59, 10
    s_add_u32 s70, s59, 13631488
    s_nop 7
    v_add_f32 v29, v80, v81
    v_add_f32 v28, v82, v83
    v_add_f32 v30, v84, v85
    v_add_f32 v31, v86, v87
    v_add_f32 v28, v28, v29
    v_add_f32 v30, v30, v31
    v_add_f32 v28, v28, v30
    v_fma_f32 v28, 0, v28, v88
    v_cmp_ngt_f32 vcc, 0x7e000000, v28
    s_nop 4
    s_cbranch_vccnz m_fallback
m_fin:
    v_rcp_f32 v28, v88
    s_nop 0
    v_mul_f32 v80, v28, v80
    v_mul_f32 v81, v28, v81
    v_mul_f32 v82, v28, v82
    v_mul_f32 v83, v28, v83
    v_mul_f32 v84, v28, v84
    v_mul_f32 v85, v28, v85
    v_mul_f32 v86, v28, v86
    v_mul_f32 v87, v28, v87
    v_cvt_pk_bf16_f32 v20, v80, v81
    v_cvt_pk_bf16_f32 v21, v82, v83
    v_cvt_pk_bf16_f32 v22, v84, v85
    v_cvt_pk_bf16_f32 v23, v86, v87
    v_min_u32 v20, -2, v20
    v_min_u32 v21, -2, v21
    v_min_u32 v22, -2, v22
    v_min_u32 v23, -2, v23
    buffer_store_dwordx4 v[20:23], v2, s[32:35], s70 offen sc1
    s_lshl_b32 s68, s40, 13
    v_add_u32 v40, s68, v2
    s_waitcnt vmcnt(4) lgkmcnt(0)
    v_mfma_f32_32x32x16_bf16 v[128:143], v[96:99], v[104:107], v[128:143]
    ds_read_b64_tr_b16 v[112:113], v202 offset:34816
    ds_read_b64_tr_b16 v[114:115], v202 offset:35840
    ds_read_b64_tr_b16 v[116:117], v203 offset:34816
    v_mfma_f32_32x32x16_bf16 v[144:159], v[100:103], v[104:107], v[144:159]
    ds_read_b64_tr_b16 v[118:119], v203 offset:35840
    v_xor_b32 v41, 32, v40
    v_xor_b32 v42, 64, v40
    s_waitcnt vmcnt(3) lgkmcnt(0)
    v_mfma_f32_32x32x16_bf16 v[128:143], v[112:115], v[108:111], v[128:143]
    ds_read_b64_tr_b16 v[96:97], v202 offset:36864
    ds_read_b64_tr_b16 v[98:99], v202 offset:37888
    ds_read_b64_tr_b16 v[100:101], v203 offset:36864
    v_mfma_f32_32x32x16_bf16 v[144:159], v[116:119], v[108:111], v[144:159]
    ds_read_b64_tr_b16 v[102:103], v203 offset:37888
    v_xor_b32 v43, 96, v40
    v_xor_b32 v44, 128, v40
    s_waitcnt vmcnt(2) lgkmcnt(0)
    v_mfma_f32_32x32x16_bf16 v[128:143], v[96:99], v[120:123], v[128:143]
    ds_read_b64_tr_b16 v[112:113], v202 offset:38912
    ds_read_b64_tr_b16 v[114:115], v202 offset:39936
    ds_read_b64_tr_b16 v[116:117], v203 offset:38912
    v_mfma_f32_32x32x16_bf16 v[144:159], v[100:103], v[120:123], v[144:159]
    ds_read_b64_tr_b16 v[118:119], v203 offset:39936
    v_xor_b32 v45, 160, v40
    v_xor_b32 v46, 192, v40
    s_waitcnt vmcnt(1) lgkmcnt(0)
    v_mfma_f32_32x32x16_bf16 v[128:143], v[112:115], v[124:127], v[128:143]
    v_xor_b32 v47, 224, v40
    v_mfma_f32_32x32x16_bf16 v[144:159], v[116:119], v[124:127], v[144:159]
    v_lshrrev_b32 v30, 3, v0
    s_lshr_b32 s68, s101, 7
    v_add_u32 v30, s68, v30
    v_lshlrev_b32 v37, 1, v229
    v_xor_b32 v30, v30, v37
    v_lshlrev_b32 v30, 4, v30
    v_lshl_add_u32 v37, v229, 10, v30
    s_lshl_b32 s68, s48, 15
    v_add_u32 v37, s68, v37
    s_nop 7
    ds_write_b128 v40, v[128:131] offset:0
    ds_write_b128 v41, v[132:135] offset:1024
    ds_write_b128 v42, v[136:139] offset:2048
    ds_write_b128 v43, v[140:143] offset:3072
    ds_write_b128 v44, v[144:147] offset:4096
    ds_write_b128 v45, v[148:151] offset:5120
    ds_write_b128 v46, v[152:155] offset:6144
    ds_write_b128 v47, v[156:159] offset:7168
    v_add_u32 v20, 65536, v40
    v_add_u32 v21, 65536, v41
    v_add_u32 v22, 65536, v42
    v_add_u32 v23, 65536, v43
    v_add_u32 v24, 65536, v44
    v_add_u32 v25, 65536, v45
    v_add_u32 v26, 65536, v46
    v_add_u32 v27, 65536, v47
    s_lshl_b32 s70, s43, 1
    s_add_u32 s70, s70, s48
    s_lshl_b32 s70, s70, 15
    s_lshl_b32 s68, s101, 3
    s_add_u32 s70, s70, s68
    s_add_u32 s70, s70, 13631488
    s_add_u32 s71, s70, 4096
    s_mov_b32 s59, 50000
    s_waitcnt vmcnt(10) lgkmcnt(0)
    s_barrier
    ds_read_b128 v[96:99], v37 offset:0
    ds_read_b128 v[100:103], v37 offset:512
    ds_read_b128 v[104:107], v37 offset:8192
    ds_read_b128 v[108:111], v37 offset:8704
    ds_read_b128 v[112:115], v37 offset:16384
    ds_read_b128 v[116:119], v37 offset:16896
    ds_read_b128 v[120:123], v37 offset:24576
    ds_read_b128 v[124:127], v37 offset:25088
    v_add_u32 v37, 65536, v37
    buffer_load_dwordx4 v[64:67], v2, s[32:35], s70 offen offset:0 sc1
    buffer_load_dwordx4 v[68:71], v2, s[32:35], s70 offen offset:1024 sc1
    buffer_load_dwordx4 v[72:75], v2, s[32:35], s70 offen offset:2048 sc1
    buffer_load_dwordx4 v[76:79], v2, s[32:35], s70 offen offset:3072 sc1
    buffer_load_dwordx4 v[80:83], v2, s[32:35], s71 offen offset:0 sc1
    buffer_load_dwordx4 v[84:87], v2, s[32:35], s71 offen offset:1024 sc1
    buffer_load_dwordx4 v[88:91], v2, s[32:35], s71 offen offset:2048 sc1
    buffer_load_dwordx4 v[92:95], v2, s[32:35], s71 offen offset:3072 sc1
    s_waitcnt lgkmcnt(0)
    v_add_f32 v40, v96, v104
    v_add_f32 v48, v112, v120
    v_add_f32 v41, v97, v105
    v_add_f32 v49, v113, v121
    v_add_f32 v42, v98, v106
    v_add_f32 v50, v114, v122
    v_add_f32 v43, v99, v107
    v_add_f32 v51, v115, v123
    v_add_f32 v44, v100, v108
    v_add_f32 v52, v116, v124
    v_add_f32 v45, v101, v109
    v_add_f32 v53, v117, v125
    v_add_f32 v46, v102, v110
    v_add_f32 v54, v118, v126
    v_add_f32 v47, v103, v111
    v_add_f32 v55, v119, v127
    v_add_f32 v56, v40, v48
    v_add_f32 v57, v41, v49
    v_add_f32 v58, v42, v50
    v_add_f32 v59, v43, v51
    v_add_f32 v60, v44, v52
    v_add_f32 v61, v45, v53
    v_add_f32 v62, v46, v54
    v_add_f32 v63, v47, v55
    v_mul_f32 v40, 0xbfb8aa3b, v56
    v_mul_f32 v41, 0xbfb8aa3b, v57
    v_mul_f32 v42, 0xbfb8aa3b, v58
    v_mul_f32 v43, 0xbfb8aa3b, v59
    v_mul_f32 v44, 0xbfb8aa3b, v60
    v_mul_f32 v45, 0xbfb8aa3b, v61
    v_mul_f32 v46, 0xbfb8aa3b, v62
    v_mul_f32 v47, 0xbfb8aa3b, v63
    v_exp_f32 v40, v40
    v_exp_f32 v41, v41
    v_exp_f32 v42, v42
    v_exp_f32 v43, v43
    v_exp_f32 v44, v44
    v_exp_f32 v45, v45
    v_exp_f32 v46, v46
    v_exp_f32 v47, v47
    v_add_f32 v40, 1.0, v40
    v_add_f32 v41, 1.0, v41
    v_add_f32 v42, 1.0, v42
    v_add_f32 v43, 1.0, v43
    v_add_f32 v44, 1.0, v44
    v_add_f32 v45, 1.0, v45
    v_add_f32 v46, 1.0, v46
    v_add_f32 v47, 1.0, v47
    v_rcp_f32 v40, v40
    v_rcp_f32 v41, v41
    v_rcp_f32 v42, v42
    v_rcp_f32 v43, v43
    v_rcp_f32 v44, v44
    v_rcp_f32 v45, v45
    v_rcp_f32 v46, v46
    v_rcp_f32 v47, v47
    v_mul_f32 v56, v56, v40
    v_mul_f32 v57, v57, v41
    v_mul_f32 v58, v58, v42
    v_mul_f32 v59, v59, v43
    v_mul_f32 v60, v60, v44
    v_mul_f32 v61, v61, v45
    v_mul_f32 v62, v62, v46
    v_mul_f32 v63, v63, v47
    v_lshlrev_b32 v40, 16, v224
    v_and_b32 v41, 0xffff0000, v224
    v_lshlrev_b32 v42, 16, v225
    v_and_b32 v43, 0xffff0000, v225
    v_lshlrev_b32 v44, 16, v226
    v_and_b32 v45, 0xffff0000, v226
    v_lshlrev_b32 v46, 16, v227
    v_and_b32 v47, 0xffff0000, v227
    s_mov_b32 s75, -2
m_oc0:
    s_waitcnt vmcnt(7)
    v_max3_u32 v38, v64, v65, v66
    v_max_u32 v38, v38, v67
    v_cmp_lt_u32 vcc, s75, v38
    s_nop 1
    s_cbranch_vccnz m_or0
    v_mfma_f32_32x32x16_bf16 v[96:111], v[160:163], v[64:67], 0
    v_mfma_f32_32x32x16_bf16 v[112:127], v[164:167], v[64:67], 0
m_oc1:
    s_waitcnt vmcnt(6)
    v_max3_u32 v38, v68, v69, v70
    v_max_u32 v38, v38, v71
    v_cmp_lt_u32 vcc, s75, v38
    s_nop 1
    s_cbranch_vccnz m_or1
    v_mfma_f32_32x32x16_bf16 v[96:111], v[168:171], v[68:71], v[96:111]
    v_mfma_f32_32x32x16_bf16 v[112:127], v[172:175], v[68:71], v[112:127]
m_oc2:
    s_waitcnt vmcnt(5)
    v_max3_u32 v38, v72, v73, v74
    v_max_u32 v38, v38, v75
    v_cmp_lt_u32 vcc, s75, v38
    s_nop 1
    s_cbranch_vccnz m_or2
    v_mfma_f32_32x32x16_bf16 v[96:111], v[176:179], v[72:75], v[96:111]
    v_mfma_f32_32x32x16_bf16 v[112:127], v[180:183], v[72:75], v[112:127]
m_oc3:
    s_waitcnt vmcnt(4)
    v_max3_u32 v38, v76, v77, v78
    v_max_u32 v38, v38, v79
    v_cmp_lt_u32 vcc, s75, v38
    s_nop 1
    s_cbranch_vccnz m_or3
    v_mfma_f32_32x32x16_bf16 v[96:111], v[184:187], v[76:79], v[96:111]
    v_mfma_f32_32x32x16_bf16 v[112:127], v[188:191], v[76:79], v[112:127]
m_oc4:
    s_waitcnt vmcnt(3)
    v_max3_u32 v38, v80, v81, v82
    v_max_u32 v38, v38, v83
    v_cmp_lt_u32 vcc, s75, v38
    s_nop 1
    s_cbranch_vccnz m_or4
    v_mfma_f32_32x32x16_bf16 v[96:111], v[208:211], v[80:83], v[96:111]
    v_mfma_f32_32x32x16_bf16 v[112:127], v[212:215], v[80:83], v[112:127]
m_oc5:
    s_waitcnt vmcnt(2)
    v_max3_u32 v38, v84, v85, v86
    v_max_u32 v38, v38, v87
    v_cmp_lt_u32 vcc, s75, v38
    s_nop 1
    s_cbranch_vccnz m_or5
    v_mfma_f32_32x32x16_bf16 v[96:111], v[216:219], v[84:87], v[96:111]
    v_mfma_f32_32x32x16_bf16 v[112:127], v[220:223], v[84:87], v[112:127]
m_oc6:
    s_waitcnt vmcnt(1)
    v_max3_u32 v38, v88, v89, v90
    v_max_u32 v38, v38, v91
    v_cmp_lt_u32 vcc, s75, v38
    s_nop 1
    s_cbranch_vccnz m_or6
    v_mfma_f32_32x32x16_bf16 v[96:111], v[232:235], v[88:91], v[96:111]
    v_mfma_f32_32x32x16_bf16 v[112:127], v[236:239], v[88:91], v[112:127]
m_oc7:
    s_waitcnt vmcnt(0)
    v_max3_u32 v38, v92, v93, v94
    v_max_u32 v38, v38, v95
    v_cmp_lt_u32 vcc, s75, v38
    s_nop 1
    s_cbranch_vccnz m_or7
    v_mfma_f32_32x32x16_bf16 v[96:111], v[240:243], v[92:95], v[96:111]
    v_mfma_f32_32x32x16_bf16 v[112:127], v[244:247], v[92:95], v[112:127]
    s_nop 5
    s_nop 5
    ds_write_b128 v20, v[96:99] offset:0
    ds_write_b128 v21, v[100:103] offset:1024
    ds_write_b128 v22, v[104:107] offset:2048
    ds_write_b128 v23, v[108:111] offset:3072
    ds_write_b128 v24, v[112:115] offset:4096
    ds_write_b128 v25, v[116:119] offset:5120
    ds_write_b128 v26, v[120:123] offset:6144
    ds_write_b128 v27, v[124:127] offset:7168
    s_waitcnt lgkmcnt(0)
    s_barrier
    ds_read_b128 v[64:67], v37 offset:0
    ds_read_b128 v[68:71], v37 offset:512
    ds_read_b128 v[72:75], v37 offset:8192
    ds_read_b128 v[76:79], v37 offset:8704
    ds_read_b128 v[80:83], v37 offset:16384
    ds_read_b128 v[84:87], v37 offset:16896
    ds_read_b128 v[88:91], v37 offset:24576
    ds_read_b128 v[92:95], v37 offset:25088
    s_waitcnt lgkmcnt(4)
    v_add_f32 v64, v64, v72
    v_add_f32 v65, v65, v73
    v_add_f32 v66, v66, v74
    v_add_f32 v67, v67, v75
    v_add_f32 v68, v68, v76
    v_add_f32 v69, v69, v77
    v_add_f32 v70, v70, v78
    v_add_f32 v71, v71, v79
    s_waitcnt lgkmcnt(0)
    v_add_f32 v80, v80, v88
    v_add_f32 v81, v81, v89
    v_add_f32 v82, v82, v90
    v_add_f32 v83, v83, v91
    v_add_f32 v84, v84, v92
    v_add_f32 v85, v85, v93
    v_add_f32 v86, v86, v94
    v_add_f32 v87, v87, v95
    v_add_f32 v64, v64, v80
    v_add_f32 v65, v65, v81
    v_add_f32 v66, v66, v82
    v_add_f32 v67, v67, v83
    v_add_f32 v68, v68, v84
    v_add_f32 v69, v69, v85
    v_add_f32 v70, v70, v86
    v_add_f32 v71, v71, v87
    v_fma_f32 v40, v64, v56, v40
    v_fma_f32 v41, v65, v57, v41
    v_fma_f32 v42, v66, v58, v42
    v_fma_f32 v43, v67, v59, v43
    v_fma_f32 v44, v68, v60, v44
    v_fma_f32 v45, v69, v61, v45
    v_fma_f32 v46, v70, v62, v46
    v_fma_f32 v47, v71, v63, v47
    v_cvt_pk_bf16_f32 v48, v40, v41
    v_cvt_pk_bf16_f32 v49, v42, v43
    v_cvt_pk_bf16_f32 v50, v44, v45
    v_cvt_pk_bf16_f32 v51, v46, v47
    buffer_store_dwordx4 v[48:51], v228, s[64:67], s57 offen sc1
    s_mov_b32 s59, 22118400
    s_cmp_eq_u32 s40, 0
    s_cselect_b32 s59, s59, 0x7ffffff0
    s_cmp_eq_u32 s2, 0
    s_cselect_b32 s59, s59, 0x7ffffff0
    v_mov_b32 v32, s58
    v_mov_b32 v33, 0
    s_mov_b64 exec, 1
    buffer_store_dword v32, v33, s[32:35], s59 offen sc1
    s_mov_b64 exec, -1
k_end:
    s_endpgm
m_or0:
    s_sub_u32 s59, s59, 1
    s_cselect_b32 s75, -1, s75
    buffer_load_dwordx4 v[64:67], v2, s[32:35], s70 offen offset:0 sc1
    buffer_load_dwordx4 v[68:71], v2, s[32:35], s70 offen offset:1024 sc1
    buffer_load_dwordx4 v[72:75], v2, s[32:35], s70 offen offset:2048 sc1
    buffer_load_dwordx4 v[76:79], v2, s[32:35], s70 offen offset:3072 sc1
    buffer_load_dwordx4 v[80:83], v2, s[32:35], s71 offen offset:0 sc1
    buffer_load_dwordx4 v[84:87], v2, s[32:35], s71 offen offset:1024 sc1
    buffer_load_dwordx4 v[88:91], v2, s[32:35], s71 offen offset:2048 sc1
    buffer_load_dwordx4 v[92:95], v2, s[32:35], s71 offen offset:3072 sc1
    s_branch m_oc0
m_or1:
    s_sub_u32 s59, s59, 1
    s_cselect_b32 s75, -1, s75
    buffer_load_dwordx4 v[68:71], v2, s[32:35], s70 offen offset:1024 sc1
    buffer_load_dwordx4 v[72:75], v2, s[32:35], s70 offen offset:2048 sc1
    buffer_load_dwordx4 v[76:79], v2, s[32:35], s70 offen offset:3072 sc1
    buffer_load_dwordx4 v[80:83], v2, s[32:35], s71 offen offset:0 sc1
    buffer_load_dwordx4 v[84:87], v2, s[32:35], s71 offen offset:1024 sc1
    buffer_load_dwordx4 v[88:91], v2, s[32:35], s71 offen offset:2048 sc1
    buffer_load_dwordx4 v[92:95], v2, s[32:35], s71 offen offset:3072 sc1
    s_branch m_oc1
m_or2:
    s_sub_u32 s59, s59, 1
    s_cselect_b32 s75, -1, s75
    buffer_load_dwordx4 v[72:75], v2, s[32:35], s70 offen offset:2048 sc1
    buffer_load_dwordx4 v[76:79], v2, s[32:35], s70 offen offset:3072 sc1
    buffer_load_dwordx4 v[80:83], v2, s[32:35], s71 offen offset:0 sc1
    buffer_load_dwordx4 v[84:87], v2, s[32:35], s71 offen offset:1024 sc1
    buffer_load_dwordx4 v[88:91], v2, s[32:35], s71 offen offset:2048 sc1
    buffer_load_dwordx4 v[92:95], v2, s[32:35], s71 offen offset:3072 sc1
    s_branch m_oc2
m_or3:
    s_sub_u32 s59, s59, 1
    s_cselect_b32 s75, -1, s75
    buffer_load_dwordx4 v[76:79], v2, s[32:35], s70 offen offset:3072 sc1
    buffer_load_dwordx4 v[80:83], v2, s[32:35], s71 offen offset:0 sc1
    buffer_load_dwordx4 v[84:87], v2, s[32:35], s71 offen offset:1024 sc1
    buffer_load_dwordx4 v[88:91], v2, s[32:35], s71 offen offset:2048 sc1
    buffer_load_dwordx4 v[92:95], v2, s[32:35], s71 offen offset:3072 sc1
    s_branch m_oc3
m_or4:
    s_sub_u32 s59, s59, 1
    s_cselect_b32 s75, -1, s75
    buffer_load_dwordx4 v[80:83], v2, s[32:35], s71 offen offset:0 sc1
    buffer_load_dwordx4 v[84:87], v2, s[32:35], s71 offen offset:1024 sc1
    buffer_load_dwordx4 v[88:91], v2, s[32:35], s71 offen offset:2048 sc1
    buffer_load_dwordx4 v[92:95], v2, s[32:35], s71 offen offset:3072 sc1
    s_branch m_oc4
m_or5:
    s_sub_u32 s59, s59, 1
    s_cselect_b32 s75, -1, s75
    buffer_load_dwordx4 v[84:87], v2, s[32:35], s71 offen offset:1024 sc1
    buffer_load_dwordx4 v[88:91], v2, s[32:35], s71 offen offset:2048 sc1
    buffer_load_dwordx4 v[92:95], v2, s[32:35], s71 offen offset:3072 sc1
    s_branch m_oc5
m_or6:
    s_sub_u32 s59, s59, 1
    s_cselect_b32 s75, -1, s75
    buffer_load_dwordx4 v[88:91], v2, s[32:35], s71 offen offset:2048 sc1
    buffer_load_dwordx4 v[92:95], v2, s[32:35], s71 offen offset:3072 sc1
    s_branch m_oc6
m_or7:
    s_sub_u32 s59, s59, 1
    s_cselect_b32 s75, -1, s75
    buffer_load_dwordx4 v[92:95], v2, s[32:35], s71 offen offset:3072 sc1
    s_branch m_oc7
p1_c1_spin:
    s_mov_b32 s59, 400000
p1_c1_l:
    s_sleep 2
    buffer_load_dword v23, v22, s[32:35], s56 offen sc1
    s_waitcnt vmcnt(0)
    v_cmp_ne_u32 vcc, s58, v23
    s_sub_u32 s59, s59, 1
    s_nop 3
    s_cbranch_vccz p1_c1_ret
    s_cmp_lg_u32 s59, 0
    s_cbranch_scc1 p1_c1_l
    s_branch p1_c1_ret
m_c2_spin:
    s_mov_b32 s59, 400000
m_c2_l:
    s_sleep 2
    buffer_load_dword v31, v30, s[32:35], s56 offen sc1
    s_waitcnt vmcnt(0)
    v_cmp_ne_u32 vcc, s58, v31
    s_sub_u32 s59, s59, 1
    s_nop 3
    s_cbranch_vccz m_c2_ret
    s_cmp_lg_u32 s59, 0
    s_cbranch_scc1 m_c2_l
    s_branch m_c2_ret
m_c3_spin:
    s_mov_b32 s59, 400000
m_c3_l:
    s_sleep 2
    buffer_load_dword v31, v30, s[32:35], s56 offen sc1
    s_waitcnt vmcnt(0)
    v_cmp_ne_u32 vcc, s58, v31
    s_sub_u32 s59, s59, 1
    s_nop 3
    s_cbranch_vccz m_c3_ret
    s_cmp_lg_u32 s59, 0
    s_cbranch_scc1 m_c3_l
    s_branch m_c3_ret
m_fallback:
    s_sub_u32 s68, s49, s101
    s_mov_b32 s69, 0
    v_mov_b32 v28, 0xff800000
    v_subrev_u32 v30, 131072, v3
m_fb1:
    buffer_load_dwordx4 v[8:11], v2, s[32:35], s68 offen sc1
    s_add_u32 s68, s68, 2048
    s_waitcnt vmcnt(0)
    v_mfma_f32_32x32x16_bf16 v[48:63], v[8:11], v[4:7], 0
    s_nop 15
    v_max3_f32 v28, v28, v48, v49
    v_max3_f32 v28, v28, v50, v51
    v_max3_f32 v28, v28, v52, v53
    v_max3_f32 v28, v28, v54, v55
    v_max3_f32 v28, v28, v56, v57
    v_max3_f32 v28, v28, v58, v59
    v_max3_f32 v28, v28, v60, v61
    v_max3_f32 v28, v28, v62, v63
    s_add_u32 s69, s69, 1
    s_cmp_lt_u32 s69, 64
    s_cbranch_scc1 m_fb1
    v_mov_b32 v29, v28
    s_nop 1
    v_permlane32_swap_b32 v28, v29
    v_max_f32 v28, v28, v29
    v_sub_f32 v32, 0, v28
    v_mov_b32 v80, 0
    v_sub_f32 v33, 0, v28
    v_mov_b32 v81, 0
    v_sub_f32 v34, 0, v28
    v_mov_b32 v82, 0
    v_sub_f32 v35, 0, v28
    v_mov_b32 v83, 0
    v_sub_f32 v36, 0, v28
    v_mov_b32 v84, 0
    v_sub_f32 v37, 0, v28
    v_mov_b32 v85, 0
    v_sub_f32 v38, 0, v28
    v_mov_b32 v86, 0
    v_sub_f32 v39, 0, v28
    v_mov_b32 v87, 0
    v_sub_f32 v40, 0, v28
    v_mov_b32 v88, 0
    v_sub_f32 v41, 0, v28
    v_mov_b32 v89, 0
    v_sub_f32 v42, 0, v28
    v_mov_b32 v90, 0
    v_sub_f32 v43, 0, v28
    v_mov_b32 v91, 0
    v_sub_f32 v44, 0, v28
    v_mov_b32 v92, 0
    v_sub_f32 v45, 0, v28
    v_mov_b32 v93, 0
    v_sub_f32 v46, 0, v28
    v_mov_b32 v94, 0
    v_sub_f32 v47, 0, v28
    v_mov_b32 v95, 0
    s_sub_u32 s68, s49, s101
    s_mov_b32 s69, 0
m_fb2:
    buffer_load_dwordx4 v[8:11], v2, s[32:35], s68 offen sc1
    s_mov_b64 exec, s[52:53]
    buffer_load_dwordx4 v[12:15], v30, s[32:35], s68 offen sc1
    buffer_load_dwordx4 v[16:19], v30, s[32:35], s68 offen offset:512 sc1
    s_mov_b64 exec, -1
    s_add_u32 s68, s68, 2048
    s_waitcnt vmcnt(0)
    v_mfma_f32_32x32x16_bf16 v[48:63], v[8:11], v[4:7], v[32:47]
    s_nop 15
    v_exp_f32 v48, v48
    v_exp_f32 v49, v49
    v_exp_f32 v50, v50
    v_exp_f32 v51, v51
    v_exp_f32 v52, v52
    v_exp_f32 v53, v53
    v_exp_f32 v54, v54
    v_exp_f32 v55, v55
    v_exp_f32 v56, v56
    v_exp_f32 v57, v57
    v_exp_f32 v58, v58
    v_exp_f32 v59, v59
    v_exp_f32 v60, v60
    v_exp_f32 v61, v61
    v_exp_f32 v62, v62
    v_exp_f32 v63, v63
    s_nop 1
    v_smfmac_f32_32x32x32_bf16 v[80:95], v[12:15], v[48:55], v207
    v_smfmac_f32_32x32x32_bf16 v[80:95], v[16:19], v[56:63], v207
    s_add_u32 s69, s69, 1
    s_cmp_lt_u32 s69, 64
    s_cbranch_scc1 m_fb2
    s_nop 15
    k_last:
    s_branch m_fin
.section .rodata,"a"
.p2align 6
.amdhsa_kernel recurrent_scan__mha_block__glu_gated_reglu__prompt_kernel
  .amdhsa_next_free_vgpr 256
  .amdhsa_next_free_sgpr 102
  .amdhsa_accum_offset 256
  .amdhsa_group_segment_fixed_size 0
  .amdhsa_kernarg_size 80
  .amdhsa_user_sgpr_count 2
  .amdhsa_user_sgpr_kernarg_segment_ptr 1
  .amdhsa_system_sgpr_workgroup_id_x 1
.end_amdhsa_kernel
```
